```python
import torch

def _softmax(x, axis=-1):
    return torch.softmax(x, dim=axis)
def _gelu(x):
    return torch.nn.functional.gelu(x, approximate="tanh")
def _silu(x):
    return torch.nn.functional.silu(x)
def _sigmoid(x):
    return torch.sigmoid(x)
def _layernorm(x, axis=-1, eps=1e-5):
    m = x.mean(dim=axis, keepdim=True)
    v = x.var(dim=axis, keepdim=True, unbiased=False)
    return (x - m) / torch.sqrt(v + eps)
def _scatter_add(tgt, idx, src, axis=0):
    return tgt.clone().index_add_(axis, idx, src)
def _segment_sum(src, seg, n):
    out = torch.zeros((n,) + src.shape[1:], dtype=src.dtype)
    return out.index_add_(0, seg, src)
def _pad(x, pw):
    flat = tuple(v for pair in reversed(pw) for v in pair)
    return torch.nn.functional.pad(x, flat)

kernel_name = 'gated_mix__ssm_conv_h3__ssm_conv_s4d__prompt'

def setup_inputs():

    _w = (lambda a: (lambda t: t.to(torch.bfloat16) if t.is_floating_point() else t)(torch.as_tensor(a)))
    def _A_setup():
        B, S, D = 1, 2048, 576
        ks = 4
        return {
            "q": _w((lambda *s: torch.randn(*s, dtype=torch.bfloat16) * 0.05)(B, S, D)),
            "k": _w((lambda *s: torch.randn(*s, dtype=torch.bfloat16) * 0.8)(B, S, D)),
            "v": _w((lambda *s: torch.randn(*s, dtype=torch.bfloat16) * 0.8)(B, S, D)),
            "shift_k": _w((lambda *s: torch.randn(*s, dtype=torch.bfloat16) * 0.8)(D, ks) * 0.5),
            "ssm_k": _w((lambda *s: torch.randn(*s, dtype=torch.bfloat16) * 0.8)(D, S) * (1.0 / S ** 0.5)),
            "ssm_D": _w((lambda *s: torch.randn(*s, dtype=torch.bfloat16) * 0.8)(D)),
        }
    _A_in = _A_setup()

    def _B_setup():
        Bsz, L, D, N = 1, 2048, 576, 128
        return {
            "u": _w((lambda *s: torch.randn(*s, dtype=torch.bfloat16) * 0.05)(Bsz, L, D)),
            "log_A_real": _w((lambda *s: torch.randn(*s, dtype=torch.bfloat16) * 3.2)(D, N) * 0.5),
            "A_imag": _w((lambda *s: torch.randn(*s, dtype=torch.bfloat16) * 0.2)(D, N) * 3.14),
            "C_real": _w((lambda *s: torch.randn(*s, dtype=torch.bfloat16) * 3.2)(D, N) / N ** 0.5),
            "C_imag": _w((lambda *s: torch.randn(*s, dtype=torch.bfloat16) * 3.2)(D, N) / N ** 0.5),
            "log_dt": _w((lambda *s: torch.randn(*s, dtype=torch.bfloat16) * 0.2)(D) * 0.5 - 4.0),
            "D_skip": _w((lambda *s: torch.randn(*s, dtype=torch.bfloat16) * 0.4)(D)),
        }
    _B_in = _B_setup()

    return {
        "A_q": _A_in["q"],
        "A_k": _A_in["k"],
        "A_v": _A_in["v"],
        "A_shift_k": _A_in["shift_k"],
        "A_ssm_k": _A_in["ssm_k"],
        "A_ssm_D": _A_in["ssm_D"],
        "B_u": _B_in["u"],
        "B_log_A_real": _B_in["log_A_real"],
        "B_A_imag": _B_in["A_imag"],
        "B_C_real": _B_in["C_real"],
        "B_C_imag": _B_in["C_imag"],
        "B_log_dt": _B_in["log_dt"],
        "B_D_skip": _B_in["D_skip"],
        "gate_w": _w((lambda *s: torch.randn(*s, dtype=torch.bfloat16) * 0.05)(576) * 16.0),
    }

def reference(A_q, A_k, A_v, A_shift_k, A_ssm_k, A_ssm_D, B_u, B_log_A_real, B_A_imag, B_C_real, B_C_imag, B_log_dt, B_D_skip, gate_w):
    def _A_ref(q, k, v, shift_k, ssm_k, ssm_D):
        B, S, D = q.shape
        ks = shift_k.shape[-1]
        k_pad = _pad(k, ((0, 0), (ks - 1, 0), (0, 0)))
        k_shift = torch.zeros_like(k)
        for t in range(ks):
            k_shift = k_shift + k_pad[:, t:t + S, :] * shift_k[:, ks - 1 - t][None, None, :]
        kv = k_shift * v
        L = 2 * S
        kv_pad = _pad(kv, ((0, 0), (0, S), (0, 0)))
        kf_pad = _pad(ssm_k, ((0, 0), (0, S)))
        kv_f = (lambda x, axes=(-2,-1): torch.fft.rfft2(x.float(), dim=axes))(kv_pad[:, None, :, :], axes=(1, 2))
        kf_f = (lambda x, axes=(-2,-1): torch.fft.rfft2(x.float(), dim=axes))(kf_pad[:, None, :], axes=(1, 2))
        kf_f = (lambda x, *d: x.permute(*d))(kf_f, 1, 2, 0)
        y_f = kv_f * kf_f[None, :, :, :]
        y = (lambda x, s, axes=(-2,-1): torch.fft.irfft2(x, s=s, dim=axes).to(torch.bfloat16))(y_f, (1, L), axes=(1, 2))[:, 0, :S, :]
        y = y + kv * ssm_D[None, None, :]
        return q * y

    def _B_ref(u, log_A_real, A_imag, C_real, C_imag, log_dt, D_skip):
        L = u.shape[1]
        dt = torch.exp(log_dt)
        A = -torch.exp(log_A_real) + 1j * A_imag
        C = (C_real + 1j * C_imag) * dt[:, None]
        pos = (lambda x, dt: x.to(dt))(torch.arange(L), log_dt.dtype)
        P = torch.exp((A * dt[:, None])[:, :, None] * pos[None, None, :])
        K = 2.0 * torch.einsum("dn,dnl->dl", C, P).real
        L2 = 2 * L
        u_t = (lambda x, *d: x.permute(*d))(u, 0, 2, 1)
        Kf = (lambda x, *a, **k: torch.fft.rfft(x.float(), *a, **k))(K, L2)
        Uf = (lambda x, *a, **k: torch.fft.rfft(x.float(), *a, **k))(u_t, L2)
        y = (lambda x, *a, **k: torch.fft.irfft(x, *a, **k).to(torch.bfloat16))(Uf * Kf[None, :, :], L2)[:, :, :L]
        y = (lambda x, *d: x.permute(*d))(y, 0, 2, 1)
        return y + u * D_skip[None, None, :]

    x = A_q
    g = _sigmoid((x * gate_w).sum(-1, keepdims=True))
    a = _A_ref(x, A_k, A_v, A_shift_k, A_ssm_k, A_ssm_D)
    b = _B_ref(x, B_log_A_real, B_A_imag, B_C_real, B_C_imag, B_log_dt, B_D_skip)
    return g * a + (1 - g) * b
```

```asm
; @launch grid=(256,1,1) block=(512,1,1) lds=158208
.amdgcn_target "amdgcn-amd-amdhsa--gfx950"
.text

.globl gated_mix__ssm_conv_h3__ssm_conv_s4d__prompt_kernel
.p2align 8
.type gated_mix__ssm_conv_h3__ssm_conv_s4d__prompt_kernel,@function
gated_mix__ssm_conv_h3__ssm_conv_s4d__prompt_kernel:

    s_cmp_ge_u32 s2, 256
    s_cbranch_scc1 L_end
    s_load_dwordx16 s[4:19], s[0:1], 0
    s_load_dwordx16 s[20:35], s[0:1], 64
    s_load_dwordx2 s[36:37], s[0:1], 128
    v_lshrrev_b32 v1, 6, v0
    v_and_b32 v2, 63, v0
    v_readfirstlane_b32 s3, v1
    s_getpc_b64 s[68:69]
L_pc:
    s_lshr_b32 s39, s2, 3
    s_and_b32 s72, s39, 3
    v_lshl_add_u32 v6, v0, 2, s72
    v_lshlrev_b32 v6, 7, v6
    v_cmp_gt_u32 vcc, L_end-L_pc, v6
    s_and_saveexec_b64 s[70:71], vcc
    s_cbranch_execz L_nopf
    global_load_dword v255, v6, s[68:69]
L_nopf:
    s_mov_b64 exec, -1
    v_and_b32 v3, 15, v2
    v_lshrrev_b32 v4, 4, v2
    s_and_b32 s38, s2, 7
    s_lshl_b32 s46, s38, 3
    s_lshr_b32 s71, s39, 2
    s_add_u32 s46, s46, s71
    s_add_u32 s46, s46, 512
    s_mov_b32 s75, 0
    s_lshl_b32 s74, s38, 11
    s_add_u32 s74, s74, 1343488
    s_cmp_ge_u32 s3, 4
    s_cbranch_scc1 L_a0
    s_cmp_eq_u32 s3, 0
    s_cbranch_scc1 L_w0
    s_setprio 3
    s_lshl_b32 s69, s38, 6
    s_lshl_b32 s68, s39, 1
    s_add_u32 s69, s69, s68
    s_add_u32 s69, s69, s3
    s_sub_u32 s69, s69, 2
    s_cmp_eq_u32 s3, 1
    s_cselect_b32 s75, s46, s69
    s_lshl_b32 s68, s75, 8
    v_lshl_add_u32 v6, v2, 2, s68
    s_lshl_b32 s68, s75, 1
    v_mov_b32 v7, s68
    s_waitcnt lgkmcnt(0)
    global_load_ushort v240, v7, s[26:27]
    global_load_dword v241, v6, s[18:19]
    global_load_dword v242, v6, s[20:21]
    global_load_dword v243, v6, s[22:23]
    global_load_dword v244, v6, s[24:25]
    s_setprio 0
    s_branch L_com
L_w0:
    s_setprio 1
    s_mul_i32 s70, s2, 9216
    v_and_b32 v9, 31, v2
    v_lshlrev_b32 v9, 2, v9
    v_add_u32 v9, 1024, v9
    v_add_u32 v10, s70, v9
    s_branch L_p1
L_a0:
    s_setprio 2
    s_lshl_b32 s70, s39, 6
    s_and_b32 s71, s3, 2
    s_lshl_b32 s71, s71, 4
    s_add_u32 s70, s70, s71
    s_mul_i32 s70, s70, 1152
    s_lshl_b32 s71, s38, 7
    s_and_b32 s72, s3, 1
    s_lshl_b32 s72, s72, 6
    s_add_u32 s71, s71, s72
    v_lshl_add_u32 v9, v3, 2, s71
    v_mul_u32_u24 v10, 9216, v4
    v_add3_u32 v10, v10, v9, s70
L_p1:
    v_subrev_u32 v11, 3456, v10
    v_max_i32 v11, 0, v11
    v_add_u32 v10, 4032, v10
    v_lshlrev_b32 v6, 2, v9
    s_waitcnt lgkmcnt(0)
    global_load_dwordx4 v[92:95], v6, s[10:11]
    global_load_dword v64, v11, s[6:7] offset:0
    global_load_dword v65, v11, s[6:7] offset:1152
    global_load_dword v66, v11, s[6:7] offset:2304
    global_load_dword v67, v10, s[6:7] offset:-4032
    global_load_dword v68, v10, s[6:7] offset:-2880
    global_load_dword v69, v10, s[6:7] offset:-1728
    global_load_dword v70, v10, s[6:7] offset:-576
    global_load_dword v71, v10, s[6:7] offset:576
    global_load_dword v72, v10, s[6:7] offset:1728
    global_load_dword v73, v10, s[6:7] offset:2880
    global_load_dword v74, v10, s[6:7] offset:4032
    global_load_dword v76, v10, s[8:9] offset:-4032
    global_load_dword v77, v10, s[8:9] offset:-2880
    global_load_dword v78, v10, s[8:9] offset:-1728
    global_load_dword v79, v10, s[8:9] offset:-576
    global_load_dword v80, v10, s[8:9] offset:576
    global_load_dword v81, v10, s[8:9] offset:1728
    global_load_dword v82, v10, s[8:9] offset:2880
    global_load_dword v83, v10, s[8:9] offset:4032
    s_cmp_eq_u32 s3, 0
    s_cbranch_scc1 L_kp
    s_setprio 0
L_kp:
    global_load_dword v75, v9, s[30:31]
    global_load_dword v84, v10, s[4:5] offset:-4032
    global_load_dword v85, v10, s[4:5] offset:-2880
    global_load_dword v86, v10, s[4:5] offset:-1728
    global_load_dword v87, v10, s[4:5] offset:-576
    global_load_dword v88, v10, s[4:5] offset:576
    global_load_dword v89, v10, s[4:5] offset:1728
    global_load_dword v90, v10, s[4:5] offset:2880
    global_load_dword v91, v10, s[4:5] offset:4032
    s_cmp_eq_u32 s3, 0
    s_cbranch_scc1 L_com
    s_cmp_eq_u32 s3, 4
    s_cbranch_scc1 L_touch
    s_lshl_b32 s69, s38, 6
    s_lshl_b32 s68, s39, 1
    s_add_u32 s69, s69, s68
    s_add_u32 s69, s69, s3
    s_sub_u32 s69, s69, 6
    s_cmp_eq_u32 s3, 5
    s_cselect_b32 s75, s46, s69
    s_lshl_b32 s69, s75, 12
    v_lshl_add_u32 v6, v2, 4, s69
    global_load_dwordx4 v[160:163], v6, s[12:13] offset:0
    global_load_dwordx4 v[164:167], v6, s[12:13] offset:1024
    global_load_dwordx4 v[168:171], v6, s[12:13] offset:2048
    global_load_dwordx4 v[172:175], v6, s[12:13] offset:3072
    s_branch L_com
L_touch:
    s_mul_i32 s68, s39, 73728
    s_add_u32 s68, s68, s71
    v_and_b32 v7, 31, v2
    v_mul_u32_u24 v6, 2304, v7
    v_add_u32 v6, s68, v6
    v_lshl_add_u32 v7, v2, 4, s74
    global_load_dword v160, v6, s[32:33] sc1
    global_load_dword v161, v6, s[32:33] offset:1152 sc1
    global_load_dword v162, v7, s[36:37] sc1
    global_load_dword v163, v7, s[36:37] offset:1024 sc1
L_com:
    s_mov_b32 s69, 1409024
    s_lshl_b32 s72, s75, 1
    s_and_b32 s72, s72, -4
    s_cmp_ge_u32 s3, 4
    s_cselect_b32 s70, s14, s28
    s_cselect_b32 s71, s15, s29
    s_load_dword s44, s[36:37], s69
    s_load_dword s16, s[70:71], s72
    v_mov_b32 v5, 149760
    s_getreg_b32 s45, hwreg(HW_REG_XCC_ID, 0, 4)
    s_mov_b32 s51, 0xffff0000
    s_lshl_b32 s68, s3, 2
    s_lshr_b32 s69, 0x10401010, s68
    s_and_b32 s69, s69, 7
    s_mul_i32 s47, s69, 8320
    s_add_u32 s47, s47, 72192
    s_mul_i32 s48, s69, 4608
    s_add_u32 s48, s48, 122112
    s_lshr_b32 s69, 0x32013210, s68
    s_and_b32 s69, s69, 7
    s_mul_i32 s49, s69, 18048
    s_lshr_b32 s69, 0x32053250, s68
    s_and_b32 s69, s69, 7
    s_mul_i32 s50, s69, 8320
    s_add_u32 s50, s50, 72192
    s_cmp_eq_u32 s3, 0
    s_cselect_b32 s50, 0, s50
    s_mov_b32 s40, s36
    s_mov_b32 s41, s37
    s_mov_b32 s42, 4194304
    s_mov_b32 s43, 0x00020000
    s_mov_b32 s96, s32
    s_mov_b32 s97, s33
    s_mov_b32 s98, 2359296
    s_mov_b32 s99, 0x00020000
    s_cmp_ge_u32 s3, 4
    s_cbranch_scc1 L_aux
    s_bfe_u32 s68, s3, 0x10001
    s_lshl_b32 s68, s68, 8
    s_add_u32 s69, s47, s68
    s_sub_u32 s70, s48, s68
    v_lshrrev_b32 v6, 1, v3
    v_lshlrev_b32 v7, 2, v4
    v_sub_u32 v6, v6, v7
    v_add_u32 v6, 13, v6
    v_lshlrev_b32 v6, 2, v6
    v_and_b32 v7, 1, v3
    v_xor_b32 v7, 1, v7
    v_mul_u32_u24 v7, 4160, v7
    v_add3_u32 v16, v6, v7, s69
    v_add_u32 v17, 1024, v16
    v_add_u32 v18, 2048, v16
    v_add_u32 v19, 3072, v16
    v_lshl_add_u32 v6, v3, 1, v4
    v_lshl_add_u32 v6, v6, 4, s70
    v_add_u32 v20, 288, v6
    v_lshrrev_b32 v6, 1, v3
    v_and_b32 v6, 3, v6
    v_xor_b32 v6, v6, v4
    v_lshl_add_u32 v6, v3, 2, v6
    v_lshl_add_u32 v21, v6, 4, s49
    v_mov_b32 v23, 1
    v_lshl_add_u32 v22, v1, 2, v5
    s_bfe_u32 s71, s3, 0x10001
    s_mul_i32 s72, s71, 768
    s_sub_u32 s72, 10416, s72
    s_and_b32 s73, s3, 1
    s_mul_i32 s73, s73, 18048
    s_add_u32 s73, s73, 52560
    s_mov_b32 s52, 0x01000100
    s_mov_b32 s53, 0x03020302
    s_mov_b32 s54, 0x05040302
    s_add_u32 s55, s49, 16928
    s_and_b32 s68, s39, 3
    s_lshl_b32 s68, s68, 7
    s_mul_i32 s69, s71, 192
    s_sub_u32 s68, s68, s69
    s_add_u32 s60, s68, 16640
    s_sub_u32 s61, 18432, s68
    v_lshl_add_u32 v7, v4, 3, 4
    v_sub_u32 v7, v7, v3
    v_med3_i32 v7, v7, 0, 17
    v_mov_b32 v8, 0x1ff
    v_lshlrev_b32 v8, v7, v8
    v_mov_b32 v9, 0xfe
    v_lshlrev_b32 v9, v7, v9
    v_bfe_u32 v52, v8, 9, 2
    v_lshl_or_b32 v52, v52, 15, v52
    v_and_b32 v52, 0x10001, v52
    v_mul_u32_u24 v52, 0x3f80, v52
    v_bfe_u32 v53, v8, 11, 2
    v_lshl_or_b32 v53, v53, 15, v53
    v_and_b32 v53, 0x10001, v53
    v_mul_u32_u24 v53, 0x3f80, v53
    v_bfe_u32 v54, v8, 13, 2
    v_lshl_or_b32 v54, v54, 15, v54
    v_and_b32 v54, 0x10001, v54
    v_mul_u32_u24 v54, 0x3f80, v54
    v_bfe_u32 v55, v8, 15, 2
    v_lshl_or_b32 v55, v55, 15, v55
    v_and_b32 v55, 0x10001, v55
    v_mul_u32_u24 v55, 0x3f80, v55
    v_bfe_u32 v56, v9, 9, 2
    v_lshl_or_b32 v56, v56, 15, v56
    v_and_b32 v56, 0x10001, v56
    v_mul_u32_u24 v56, 0x3f80, v56
    v_bfe_u32 v57, v9, 11, 2
    v_lshl_or_b32 v57, v57, 15, v57
    v_and_b32 v57, 0x10001, v57
    v_mul_u32_u24 v57, 0x3f80, v57
    v_bfe_u32 v58, v9, 13, 2
    v_lshl_or_b32 v58, v58, 15, v58
    v_and_b32 v58, 0x10001, v58
    v_mul_u32_u24 v58, 0x3f80, v58
    v_bfe_u32 v59, v9, 15, 2
    v_lshl_or_b32 v59, v59, 15, v59
    v_and_b32 v59, 0x10001, v59
    v_mul_u32_u24 v59, 0x3f80, v59
    v_subrev_u32 v7, 8, v7
    v_med3_i32 v7, v7, 0, 8
    v_bfm_b32 v8, v7, 0
    v_bfe_u32 v28, v8, 0, 2
    v_lshl_or_b32 v28, v28, 15, v28
    v_and_b32 v28, 0x10001, v28
    v_mul_u32_u24 v28, 0xffff, v28
    v_bfe_u32 v29, v8, 2, 2
    v_lshl_or_b32 v29, v29, 15, v29
    v_and_b32 v29, 0x10001, v29
    v_mul_u32_u24 v29, 0xffff, v29
    v_bfe_u32 v30, v8, 4, 2
    v_lshl_or_b32 v30, v30, 15, v30
    v_and_b32 v30, 0x10001, v30
    v_mul_u32_u24 v30, 0xffff, v30
    v_bfe_u32 v31, v8, 6, 2
    v_lshl_or_b32 v31, v31, 15, v31
    v_and_b32 v31, 0x10001, v31
    v_mul_u32_u24 v31, 0xffff, v31
    v_add_u32 v60, s72, v20
    v_lshlrev_b32 v7, 2, v4
    v_sub_u32 v7, v3, v7
    v_lshl_add_u32 v61, v7, 2, s73
    s_cmp_eq_u32 s3, 0
    s_cbranch_scc1 L_w0b
L_kgen:
    s_mov_b32 m0, s49
    v_mul_u32_u24 v13, 288, v3
    v_lshl_add_u32 v13, v4, 4, v13
    v_add_u32 v13, s49, v13
    v_mov_b32 v14, 0x3f80
    ds_write_addtid_b32 v14 offset:11808
    v_mov_b32 v14, 0
    v_mov_b32 v15, s50
    ds_write_b32 v15, v14 offset:28
    s_add_u32 s68, s49, 16416
    v_lshlrev_b32 v70, 7, v4
    v_lshl_add_u32 v10, v3, 3, v70
    v_add_u32 v11, 4, v10
    v_lshl_add_u32 v12, v3, 2, v70
    v_add_u32 v71, 64, v12
    v_cmp_gt_u32 vcc, 32, v2
    v_lshl_add_u32 v70, v3, 1, v70
    v_add_u32 v70, s68, v70
    v_cndmask_b32 v10, v12, v10, vcc
    v_cndmask_b32 v11, v71, v11, vcc
    v_add_u32 v10, s68, v10
    v_add_u32 v11, s68, v11
    v_lshrrev_b32 v71, 1, v4
    v_lshlrev_b32 v71, 8, v71
    v_lshl_add_u32 v71, v3, 4, v71
    v_and_b32 v14, 1, v4
    v_lshl_add_u32 v71, v14, 3, v71
    v_add_u32 v71, s50, v71
    s_mov_b32 s68, 0x3fb8aa00
    s_mov_b32 s69, 0x36eca570
    s_mov_b32 s70, 0xbfb8aa3b
    s_mov_b32 s71, 0x3e22f983
    s_mov_b32 s72, 0
    s_waitcnt vmcnt(0)
    v_lshlrev_b32 v240, 16, v240
    v_mul_f32 v88, s68, v240
    v_rndne_f32 v89, v88
    v_sub_f32 v88, v88, v89
    v_fma_f32 v88, s69, v240, v88
    v_exp_f32 v88, v88
    v_cvt_i32_f32 v89, v89
    v_ldexp_f32 v240, v88, v89
    v_cvt_pk_bf16_f32 v240, v240, v240
    v_and_b32 v240, s51, v240

    v_lshlrev_b32 v14, 16, v241
    v_mul_f32 v88, s68, v14
    v_rndne_f32 v89, v88
    v_sub_f32 v88, v88, v89
    v_fma_f32 v88, s69, v14, v88
    v_exp_f32 v88, v88
    v_cvt_i32_f32 v89, v89
    v_ldexp_f32 v14, v88, v89
    v_cvt_pk_bf16_f32 v14, v14, v14
    v_lshlrev_b32 v15, 16, v242
    v_and_b32 v14, s51, v14
    v_mul_f32 v15, v15, v240
    v_mul_f32 v14, v14, v240
    v_mul_f32 v15, s71, v15
    v_mul_f32 v14, s70, v14
    v_lshlrev_b32 v82, 16, v243
    v_lshlrev_b32 v83, 16, v244
    v_add_f32 v88, v240, v240
    v_mul_f32 v82, v82, v88
    v_mul_f32 v83, v83, v88
    v_mul_f32 v64, 0x41000000, v14
    v_mul_f32 v65, 0xc1000000, v15
    v_exp_f32 v64, v64
    v_fract_f32 v65, v65
    v_cos_f32 v74, v65
    v_sin_f32 v75, v65
    v_exp_f32 v66, v14
    v_fract_f32 v67, v15
    v_cos_f32 v72, v67
    v_sin_f32 v73, v67
    v_mul_f32 v68, 0x43000000, v14
    v_mul_f32 v69, 0x43000000, v15
    v_exp_f32 v68, v68
    v_fract_f32 v69, v69
    v_cos_f32 v76, v69
    v_sin_f32 v77, v69
    v_lshrrev_b32 v241, 16, v241
    v_lshrrev_b32 v242, 16, v242
    v_lshrrev_b32 v243, 16, v243
    v_lshrrev_b32 v244, 16, v244
    s_branch L_kg_gen
L_kg_it:
    v_lshlrev_b32 v14, 16, v241
    v_mul_f32 v88, s68, v14
    v_rndne_f32 v89, v88
    v_sub_f32 v88, v88, v89
    v_fma_f32 v88, s69, v14, v88
    v_exp_f32 v88, v88
    v_cvt_i32_f32 v89, v89
    v_ldexp_f32 v14, v88, v89
    v_cvt_pk_bf16_f32 v14, v14, v14
    v_lshlrev_b32 v15, 16, v242
    v_and_b32 v14, s51, v14
    v_mul_f32 v15, v15, v240
    s_waitcnt lgkmcnt(12)
    v_mfma_f32_16x16x32_bf16 v[96:99], v[128:131], v[140:143], 0
    v_mul_f32 v14, v14, v240
    v_mul_f32 v15, s71, v15
    v_mfma_f32_16x16x32_bf16 v[100:103], v[132:135], v[140:143], 0
    v_mul_f32 v14, s70, v14
    v_lshlrev_b32 v82, 16, v243
    v_mfma_f32_16x16x32_bf16 v[104:107], v[136:139], v[140:143], 0
    v_lshlrev_b32 v83, 16, v244
    v_add_f32 v88, v240, v240
    s_waitcnt lgkmcnt(8)
    v_mfma_f32_16x16x32_bf16 v[96:99], v[144:147], v[156:159], v[96:99]
    v_mul_f32 v82, v82, v88
    v_mul_f32 v83, v83, v88
    v_mfma_f32_16x16x32_bf16 v[100:103], v[148:151], v[156:159], v[100:103]
    v_mul_f32 v64, 0x41000000, v14
    v_mul_f32 v65, 0xc1000000, v15
    v_mfma_f32_16x16x32_bf16 v[104:107], v[152:155], v[156:159], v[104:107]
    v_exp_f32 v64, v64
    v_fract_f32 v65, v65
    s_waitcnt lgkmcnt(4)
    v_mfma_f32_16x16x32_bf16 v[96:99], v[160:163], v[172:175], v[96:99]
    v_cos_f32 v74, v65
    v_sin_f32 v75, v65
    v_mfma_f32_16x16x32_bf16 v[100:103], v[164:167], v[172:175], v[100:103]
    v_exp_f32 v66, v14
    v_fract_f32 v67, v15
    v_mfma_f32_16x16x32_bf16 v[104:107], v[168:171], v[172:175], v[104:107]
    v_cos_f32 v72, v67
    v_sin_f32 v73, v67
    s_waitcnt lgkmcnt(0)
    v_mfma_f32_16x16x32_bf16 v[96:99], v[176:179], v[188:191], v[96:99]
    v_mul_f32 v68, 0x43000000, v14
    v_mul_f32 v69, 0x43000000, v15
    v_mfma_f32_16x16x32_bf16 v[100:103], v[180:183], v[188:191], v[100:103]
    v_exp_f32 v68, v68
    v_fract_f32 v69, v69
    v_mfma_f32_16x16x32_bf16 v[104:107], v[184:187], v[188:191], v[104:107]
    v_cos_f32 v76, v69
    v_sin_f32 v77, v69
    .p2align 3
L_kg_gen:
    v_pk_mul_f32 v[74:75], v[74:75], v[64:65] op_sel_hi:[1,0]
    v_pk_mul_f32 v[72:73], v[72:73], v[66:67] op_sel_hi:[1,0]
    v_pk_mul_f32 v[76:77], v[76:77], v[68:69] op_sel_hi:[1,0]
    v_cvt_pk_bf16_f32 v108, v74, v75
    v_pk_mul_f32 v[86:87], v[74:75], v[74:75] op_sel_hi:[1,0]
    v_pk_fma_f32 v[84:85], v[74:75], v[74:75], v[86:87] op_sel:[1,1,0] op_sel_hi:[0,1,1] neg_lo:[1,0,0]
    v_cvt_pk_bf16_f32 v109, v84, v85
    v_pk_mul_f32 v[86:87], v[84:85], v[74:75] op_sel_hi:[1,0]
    v_pk_fma_f32 v[84:85], v[84:85], v[74:75], v[86:87] op_sel:[1,1,0] op_sel_hi:[0,1,1] neg_lo:[1,0,0]
    v_cvt_pk_bf16_f32 v110, v84, v85
    v_pk_mul_f32 v[86:87], v[84:85], v[74:75] op_sel_hi:[1,0]
    v_pk_fma_f32 v[84:85], v[84:85], v[74:75], v[86:87] op_sel:[1,1,0] op_sel_hi:[0,1,1] neg_lo:[1,0,0]
    v_cvt_pk_bf16_f32 v111, v84, v85
    v_pk_mul_f32 v[86:87], v[84:85], v[74:75] op_sel_hi:[1,0]
    v_pk_fma_f32 v[84:85], v[84:85], v[74:75], v[86:87] op_sel:[1,1,0] op_sel_hi:[0,1,1] neg_lo:[1,0,0]
    v_cvt_pk_bf16_f32 v112, v84, v85
    v_pk_mul_f32 v[86:87], v[84:85], v[74:75] op_sel_hi:[1,0]
    v_pk_fma_f32 v[84:85], v[84:85], v[74:75], v[86:87] op_sel:[1,1,0] op_sel_hi:[0,1,1] neg_lo:[1,0,0]
    v_cvt_pk_bf16_f32 v113, v84, v85
    v_pk_mul_f32 v[86:87], v[84:85], v[74:75] op_sel_hi:[1,0]
    v_pk_fma_f32 v[84:85], v[84:85], v[74:75], v[86:87] op_sel:[1,1,0] op_sel_hi:[0,1,1] neg_lo:[1,0,0]
    v_cvt_pk_bf16_f32 v114, v84, v85
    v_pk_mul_f32 v[86:87], v[84:85], v[74:75] op_sel_hi:[1,0]
    v_pk_fma_f32 v[84:85], v[84:85], v[74:75], v[86:87] op_sel:[1,1,0] op_sel_hi:[0,1,1] neg_lo:[1,0,0]
    v_cvt_pk_bf16_f32 v115, v84, v85
    v_pk_mul_f32 v[86:87], v[84:85], v[74:75] op_sel_hi:[1,0]
    v_pk_fma_f32 v[84:85], v[84:85], v[74:75], v[86:87] op_sel:[1,1,0] op_sel_hi:[0,1,1] neg_lo:[1,0,0]
    v_cvt_pk_bf16_f32 v116, v84, v85
    v_pk_mul_f32 v[86:87], v[84:85], v[74:75] op_sel_hi:[1,0]
    v_pk_fma_f32 v[84:85], v[84:85], v[74:75], v[86:87] op_sel:[1,1,0] op_sel_hi:[0,1,1] neg_lo:[1,0,0]
    v_cvt_pk_bf16_f32 v117, v84, v85
    v_pk_mul_f32 v[86:87], v[84:85], v[74:75] op_sel_hi:[1,0]
    v_pk_fma_f32 v[84:85], v[84:85], v[74:75], v[86:87] op_sel:[1,1,0] op_sel_hi:[0,1,1] neg_lo:[1,0,0]
    v_cvt_pk_bf16_f32 v118, v84, v85
    v_pk_mul_f32 v[86:87], v[84:85], v[74:75] op_sel_hi:[1,0]
    v_pk_fma_f32 v[84:85], v[84:85], v[74:75], v[86:87] op_sel:[1,1,0] op_sel_hi:[0,1,1] neg_lo:[1,0,0]
    v_cvt_pk_bf16_f32 v119, v84, v85
    v_pk_mul_f32 v[86:87], v[84:85], v[74:75] op_sel_hi:[1,0]
    v_pk_fma_f32 v[84:85], v[84:85], v[74:75], v[86:87] op_sel:[1,1,0] op_sel_hi:[0,1,1] neg_lo:[1,0,0]
    v_cvt_pk_bf16_f32 v120, v84, v85
    v_pk_mul_f32 v[86:87], v[84:85], v[74:75] op_sel_hi:[1,0]
    v_pk_fma_f32 v[84:85], v[84:85], v[74:75], v[86:87] op_sel:[1,1,0] op_sel_hi:[0,1,1] neg_lo:[1,0,0]
    v_cvt_pk_bf16_f32 v121, v84, v85
    v_pk_mul_f32 v[86:87], v[84:85], v[74:75] op_sel_hi:[1,0]
    v_pk_fma_f32 v[84:85], v[84:85], v[74:75], v[86:87] op_sel:[1,1,0] op_sel_hi:[0,1,1] neg_lo:[1,0,0]
    v_cvt_pk_bf16_f32 v122, v84, v85
    v_pk_mul_f32 v[86:87], v[72:73], v[72:73] op_sel_hi:[1,0]
    v_pk_fma_f32 v[78:79], v[72:73], v[72:73], v[86:87] op_sel:[1,1,0] op_sel_hi:[0,1,1] neg_lo:[1,0,0]
    v_pk_mul_f32 v[86:87], v[78:79], v[78:79] op_sel_hi:[1,0]
    v_pk_fma_f32 v[80:81], v[78:79], v[78:79], v[86:87] op_sel:[1,1,0] op_sel_hi:[0,1,1] neg_lo:[1,0,0]
    v_cvt_pk_bf16_f32 v192, v82, v83
    v_pk_mul_f32 v[86:87], v[82:83], v[72:73] op_sel_hi:[1,0]
    v_pk_fma_f32 v[84:85], v[82:83], v[72:73], v[86:87] op_sel:[1,1,0] op_sel_hi:[0,1,1] neg_lo:[1,0,0]
    v_cvt_pk_bf16_f32 v193, v84, v85
    v_pk_mul_f32 v[86:87], v[84:85], v[72:73] op_sel_hi:[1,0]
    v_pk_fma_f32 v[84:85], v[84:85], v[72:73], v[86:87] op_sel:[1,1,0] op_sel_hi:[0,1,1] neg_lo:[1,0,0]
    v_cvt_pk_bf16_f32 v194, v84, v85
    v_pk_mul_f32 v[86:87], v[84:85], v[72:73] op_sel_hi:[1,0]
    v_pk_fma_f32 v[84:85], v[84:85], v[72:73], v[86:87] op_sel:[1,1,0] op_sel_hi:[0,1,1] neg_lo:[1,0,0]
    v_cvt_pk_bf16_f32 v195, v84, v85
    v_pk_mul_f32 v[86:87], v[84:85], v[72:73] op_sel_hi:[1,0]
    v_pk_fma_f32 v[84:85], v[84:85], v[72:73], v[86:87] op_sel:[1,1,0] op_sel_hi:[0,1,1] neg_lo:[1,0,0]
    v_cvt_pk_bf16_f32 v196, v84, v85
    v_pk_mul_f32 v[86:87], v[84:85], v[72:73] op_sel_hi:[1,0]
    v_pk_fma_f32 v[84:85], v[84:85], v[72:73], v[86:87] op_sel:[1,1,0] op_sel_hi:[0,1,1] neg_lo:[1,0,0]
    v_cvt_pk_bf16_f32 v197, v84, v85
    v_pk_mul_f32 v[86:87], v[84:85], v[72:73] op_sel_hi:[1,0]
    v_pk_fma_f32 v[84:85], v[84:85], v[72:73], v[86:87] op_sel:[1,1,0] op_sel_hi:[0,1,1] neg_lo:[1,0,0]
    v_cvt_pk_bf16_f32 v198, v84, v85
    v_pk_mul_f32 v[86:87], v[84:85], v[72:73] op_sel_hi:[1,0]
    v_pk_fma_f32 v[84:85], v[84:85], v[72:73], v[86:87] op_sel:[1,1,0] op_sel_hi:[0,1,1] neg_lo:[1,0,0]
    v_cvt_pk_bf16_f32 v199, v84, v85
    v_pk_mul_f32 v[86:87], v[82:83], v[76:77] op_sel_hi:[1,0]
    v_pk_fma_f32 v[82:83], v[82:83], v[76:77], v[86:87] op_sel:[1,1,0] op_sel_hi:[0,1,1] neg_lo:[1,0,0]
    v_cvt_pk_bf16_f32 v200, v82, v83
    v_pk_mul_f32 v[86:87], v[82:83], v[72:73] op_sel_hi:[1,0]
    v_pk_fma_f32 v[84:85], v[82:83], v[72:73], v[86:87] op_sel:[1,1,0] op_sel_hi:[0,1,1] neg_lo:[1,0,0]
    v_cvt_pk_bf16_f32 v201, v84, v85
    v_pk_mul_f32 v[86:87], v[84:85], v[72:73] op_sel_hi:[1,0]
    v_pk_fma_f32 v[84:85], v[84:85], v[72:73], v[86:87] op_sel:[1,1,0] op_sel_hi:[0,1,1] neg_lo:[1,0,0]
    v_cvt_pk_bf16_f32 v202, v84, v85
    v_pk_mul_f32 v[86:87], v[84:85], v[72:73] op_sel_hi:[1,0]
    v_pk_fma_f32 v[84:85], v[84:85], v[72:73], v[86:87] op_sel:[1,1,0] op_sel_hi:[0,1,1] neg_lo:[1,0,0]
    v_cvt_pk_bf16_f32 v203, v84, v85
    v_pk_mul_f32 v[86:87], v[84:85], v[72:73] op_sel_hi:[1,0]
    v_pk_fma_f32 v[84:85], v[84:85], v[72:73], v[86:87] op_sel:[1,1,0] op_sel_hi:[0,1,1] neg_lo:[1,0,0]
    v_cvt_pk_bf16_f32 v204, v84, v85
    v_pk_mul_f32 v[86:87], v[84:85], v[72:73] op_sel_hi:[1,0]
    v_pk_fma_f32 v[84:85], v[84:85], v[72:73], v[86:87] op_sel:[1,1,0] op_sel_hi:[0,1,1] neg_lo:[1,0,0]
    v_cvt_pk_bf16_f32 v205, v84, v85
    v_pk_mul_f32 v[86:87], v[84:85], v[72:73] op_sel_hi:[1,0]
    v_pk_fma_f32 v[84:85], v[84:85], v[72:73], v[86:87] op_sel:[1,1,0] op_sel_hi:[0,1,1] neg_lo:[1,0,0]
    v_cvt_pk_bf16_f32 v206, v84, v85
    v_pk_mul_f32 v[86:87], v[84:85], v[72:73] op_sel_hi:[1,0]
    v_pk_fma_f32 v[84:85], v[84:85], v[72:73], v[86:87] op_sel:[1,1,0] op_sel_hi:[0,1,1] neg_lo:[1,0,0]
    v_cvt_pk_bf16_f32 v207, v84, v85
    v_pk_mul_f32 v[86:87], v[82:83], v[76:77] op_sel_hi:[1,0]
    v_pk_fma_f32 v[82:83], v[82:83], v[76:77], v[86:87] op_sel:[1,1,0] op_sel_hi:[0,1,1] neg_lo:[1,0,0]
    v_cvt_pk_bf16_f32 v208, v82, v83
    v_pk_mul_f32 v[86:87], v[82:83], v[78:79] op_sel_hi:[1,0]
    v_pk_fma_f32 v[84:85], v[82:83], v[78:79], v[86:87] op_sel:[1,1,0] op_sel_hi:[0,1,1] neg_lo:[1,0,0]
    v_cvt_pk_bf16_f32 v209, v84, v85
    v_pk_mul_f32 v[86:87], v[84:85], v[78:79] op_sel_hi:[1,0]
    v_pk_fma_f32 v[84:85], v[84:85], v[78:79], v[86:87] op_sel:[1,1,0] op_sel_hi:[0,1,1] neg_lo:[1,0,0]
    v_cvt_pk_bf16_f32 v210, v84, v85
    v_pk_mul_f32 v[86:87], v[84:85], v[78:79] op_sel_hi:[1,0]
    v_pk_fma_f32 v[84:85], v[84:85], v[78:79], v[86:87] op_sel:[1,1,0] op_sel_hi:[0,1,1] neg_lo:[1,0,0]
    v_cvt_pk_bf16_f32 v211, v84, v85
    v_pk_mul_f32 v[86:87], v[82:83], v[76:77] op_sel_hi:[1,0]
    v_pk_fma_f32 v[82:83], v[82:83], v[76:77], v[86:87] op_sel:[1,1,0] op_sel_hi:[0,1,1] neg_lo:[1,0,0]
    v_cvt_pk_bf16_f32 v212, v82, v83
    v_pk_mul_f32 v[86:87], v[82:83], v[78:79] op_sel_hi:[1,0]
    v_pk_fma_f32 v[84:85], v[82:83], v[78:79], v[86:87] op_sel:[1,1,0] op_sel_hi:[0,1,1] neg_lo:[1,0,0]
    v_cvt_pk_bf16_f32 v213, v84, v85
    v_pk_mul_f32 v[86:87], v[84:85], v[78:79] op_sel_hi:[1,0]
    v_pk_fma_f32 v[84:85], v[84:85], v[78:79], v[86:87] op_sel:[1,1,0] op_sel_hi:[0,1,1] neg_lo:[1,0,0]
    v_cvt_pk_bf16_f32 v214, v84, v85
    v_pk_mul_f32 v[86:87], v[84:85], v[78:79] op_sel_hi:[1,0]
    v_pk_fma_f32 v[84:85], v[84:85], v[78:79], v[86:87] op_sel:[1,1,0] op_sel_hi:[0,1,1] neg_lo:[1,0,0]
    v_cvt_pk_bf16_f32 v215, v84, v85
    v_pk_mul_f32 v[86:87], v[82:83], v[76:77] op_sel_hi:[1,0]
    v_pk_fma_f32 v[82:83], v[82:83], v[76:77], v[86:87] op_sel:[1,1,0] op_sel_hi:[0,1,1] neg_lo:[1,0,0]
    v_cvt_pk_bf16_f32 v216, v82, v83
    v_pk_mul_f32 v[86:87], v[82:83], v[80:81] op_sel_hi:[1,0]
    v_pk_fma_f32 v[84:85], v[82:83], v[80:81], v[86:87] op_sel:[1,1,0] op_sel_hi:[0,1,1] neg_lo:[1,0,0]
    v_cvt_pk_bf16_f32 v217, v84, v85
    v_pk_mul_f32 v[86:87], v[82:83], v[76:77] op_sel_hi:[1,0]
    v_pk_fma_f32 v[82:83], v[82:83], v[76:77], v[86:87] op_sel:[1,1,0] op_sel_hi:[0,1,1] neg_lo:[1,0,0]
    v_cvt_pk_bf16_f32 v218, v82, v83
    v_pk_mul_f32 v[86:87], v[82:83], v[80:81] op_sel_hi:[1,0]
    v_pk_fma_f32 v[84:85], v[82:83], v[80:81], v[86:87] op_sel:[1,1,0] op_sel_hi:[0,1,1] neg_lo:[1,0,0]
    v_cvt_pk_bf16_f32 v219, v84, v85
    v_pk_mul_f32 v[86:87], v[82:83], v[76:77] op_sel_hi:[1,0]
    v_pk_fma_f32 v[82:83], v[82:83], v[76:77], v[86:87] op_sel:[1,1,0] op_sel_hi:[0,1,1] neg_lo:[1,0,0]
    v_cvt_pk_bf16_f32 v220, v82, v83
    v_pk_mul_f32 v[86:87], v[82:83], v[80:81] op_sel_hi:[1,0]
    v_pk_fma_f32 v[84:85], v[82:83], v[80:81], v[86:87] op_sel:[1,1,0] op_sel_hi:[0,1,1] neg_lo:[1,0,0]
    v_cvt_pk_bf16_f32 v221, v84, v85
    v_pk_mul_f32 v[86:87], v[82:83], v[76:77] op_sel_hi:[1,0]
    v_pk_fma_f32 v[82:83], v[82:83], v[76:77], v[86:87] op_sel:[1,1,0] op_sel_hi:[0,1,1] neg_lo:[1,0,0]
    v_cvt_pk_bf16_f32 v222, v82, v83
    v_pk_mul_f32 v[86:87], v[82:83], v[80:81] op_sel_hi:[1,0]
    v_pk_fma_f32 v[84:85], v[82:83], v[80:81], v[86:87] op_sel:[1,1,0] op_sel_hi:[0,1,1] neg_lo:[1,0,0]
    v_cvt_pk_bf16_f32 v223, v84, v85
    v_pk_mul_f32 v[86:87], v[82:83], v[76:77] op_sel_hi:[1,0]
    v_pk_fma_f32 v[82:83], v[82:83], v[76:77], v[86:87] op_sel:[1,1,0] op_sel_hi:[0,1,1] neg_lo:[1,0,0]
    v_cvt_pk_bf16_f32 v224, v82, v83
    v_pk_mul_f32 v[86:87], v[82:83], v[76:77] op_sel_hi:[1,0]
    v_pk_fma_f32 v[82:83], v[82:83], v[76:77], v[86:87] op_sel:[1,1,0] op_sel_hi:[0,1,1] neg_lo:[1,0,0]
    v_cvt_pk_bf16_f32 v225, v82, v83
    v_pk_mul_f32 v[86:87], v[82:83], v[76:77] op_sel_hi:[1,0]
    v_pk_fma_f32 v[82:83], v[82:83], v[76:77], v[86:87] op_sel:[1,1,0] op_sel_hi:[0,1,1] neg_lo:[1,0,0]
    v_cvt_pk_bf16_f32 v226, v82, v83
    v_pk_mul_f32 v[86:87], v[82:83], v[76:77] op_sel_hi:[1,0]
    v_pk_fma_f32 v[82:83], v[82:83], v[76:77], v[86:87] op_sel:[1,1,0] op_sel_hi:[0,1,1] neg_lo:[1,0,0]
    v_cvt_pk_bf16_f32 v227, v82, v83
    v_pk_mul_f32 v[86:87], v[82:83], v[76:77] op_sel_hi:[1,0]
    v_pk_fma_f32 v[82:83], v[82:83], v[76:77], v[86:87] op_sel:[1,1,0] op_sel_hi:[0,1,1] neg_lo:[1,0,0]
    v_cvt_pk_bf16_f32 v228, v82, v83
    v_pk_mul_f32 v[86:87], v[82:83], v[76:77] op_sel_hi:[1,0]
    v_pk_fma_f32 v[82:83], v[82:83], v[76:77], v[86:87] op_sel:[1,1,0] op_sel_hi:[0,1,1] neg_lo:[1,0,0]
    v_cvt_pk_bf16_f32 v229, v82, v83
    v_pk_mul_f32 v[86:87], v[82:83], v[76:77] op_sel_hi:[1,0]
    v_pk_fma_f32 v[82:83], v[82:83], v[76:77], v[86:87] op_sel:[1,1,0] op_sel_hi:[0,1,1] neg_lo:[1,0,0]
    v_cvt_pk_bf16_f32 v230, v82, v83
    v_pk_mul_f32 v[86:87], v[82:83], v[76:77] op_sel_hi:[1,0]
    v_pk_fma_f32 v[82:83], v[82:83], v[76:77], v[86:87] op_sel:[1,1,0] op_sel_hi:[0,1,1] neg_lo:[1,0,0]
    v_cvt_pk_bf16_f32 v231, v82, v83
    v_pk_mul_f32 v[86:87], v[82:83], v[76:77] op_sel_hi:[1,0]
    v_pk_fma_f32 v[82:83], v[82:83], v[76:77], v[86:87] op_sel:[1,1,0] op_sel_hi:[0,1,1] neg_lo:[1,0,0]
    v_cvt_pk_bf16_f32 v232, v82, v83
    ds_write_addtid_b32 v108 offset:12096
    ds_write_addtid_b32 v109 offset:12384
    ds_write_addtid_b32 v110 offset:12672
    ds_write_addtid_b32 v111 offset:12960
    ds_write_addtid_b32 v112 offset:13248
    ds_write_addtid_b32 v113 offset:13536
    ds_write_addtid_b32 v114 offset:13824
    ds_write_addtid_b32 v115 offset:14112
    ds_write_addtid_b32 v116 offset:14400
    ds_write_addtid_b32 v117 offset:14688
    ds_write_addtid_b32 v118 offset:14976
    ds_write_addtid_b32 v119 offset:15264
    ds_write_addtid_b32 v120 offset:15552
    ds_write_addtid_b32 v121 offset:15840
    ds_write_addtid_b32 v122 offset:16128
    ds_write_addtid_b32 v192 offset:0
    ds_write_addtid_b32 v193 offset:288
    ds_write_addtid_b32 v194 offset:576
    ds_write_addtid_b32 v195 offset:864
    ds_write_addtid_b32 v196 offset:1152
    ds_write_addtid_b32 v197 offset:1440
    ds_write_addtid_b32 v198 offset:1728
    ds_write_addtid_b32 v199 offset:2016
    ds_write_addtid_b32 v200 offset:2304
    ds_write_addtid_b32 v201 offset:2592
    ds_write_addtid_b32 v202 offset:2880
    ds_write_addtid_b32 v203 offset:3168
    ds_write_addtid_b32 v204 offset:3456
    ds_write_addtid_b32 v205 offset:3744
    ds_write_addtid_b32 v206 offset:4032
    ds_write_addtid_b32 v207 offset:4320
    ds_write_addtid_b32 v208 offset:4608
    ds_write_addtid_b32 v209 offset:4896
    ds_write_addtid_b32 v210 offset:5184
    ds_write_addtid_b32 v211 offset:5472
    ds_write_addtid_b32 v212 offset:5760
    ds_write_addtid_b32 v213 offset:6048
    ds_write_addtid_b32 v214 offset:6336
    ds_write_addtid_b32 v215 offset:6624
    ds_write_addtid_b32 v216 offset:6912
    ds_write_addtid_b32 v217 offset:7200
    ds_write_addtid_b32 v218 offset:7488
    ds_write_addtid_b32 v219 offset:7776
    ds_write_addtid_b32 v220 offset:8064
    ds_write_addtid_b32 v221 offset:8352
    ds_write_addtid_b32 v222 offset:8640
    ds_write_addtid_b32 v223 offset:8928
    ds_write_addtid_b32 v224 offset:9216
    ds_write_addtid_b32 v225 offset:9504
    ds_write_addtid_b32 v226 offset:9792
    ds_write_addtid_b32 v227 offset:10080
    ds_write_addtid_b32 v228 offset:10368
    ds_write_addtid_b32 v229 offset:10656
    ds_write_addtid_b32 v230 offset:10944
    ds_write_addtid_b32 v231 offset:11232
    ds_write_addtid_b32 v232 offset:11520
    ds_read_b128 v[140:143], v13 offset:11808
    ds_read_b128 v[128:131], v13 offset:0
    ds_read_b128 v[132:135], v13 offset:4608
    ds_read_b128 v[136:139], v13 offset:9216
    ds_read_b128 v[156:159], v13 offset:11872
    ds_read_b128 v[144:147], v13 offset:64
    ds_read_b128 v[148:151], v13 offset:4672
    ds_read_b128 v[152:155], v13 offset:9280
    ds_read_b128 v[172:175], v13 offset:11936
    ds_read_b128 v[160:163], v13 offset:128
    ds_read_b128 v[164:167], v13 offset:4736
    ds_read_b128 v[168:171], v13 offset:9344
    ds_read_b128 v[188:191], v13 offset:12000
    ds_read_b128 v[176:179], v13 offset:192
    ds_read_b128 v[180:183], v13 offset:4800
    ds_read_b128 v[184:187], v13 offset:9408
    s_add_u32 s72, s72, 1
    s_cmp_lt_u32 s72, 2
    s_cbranch_scc1 L_kg_it
    s_waitcnt lgkmcnt(12)
    v_mfma_f32_16x16x32_bf16 v[96:99], v[128:131], v[140:143], v[96:99]
    v_mfma_f32_16x16x32_bf16 v[100:103], v[132:135], v[140:143], v[100:103]
    v_mfma_f32_16x16x32_bf16 v[104:107], v[136:139], v[140:143], v[104:107]
    s_waitcnt lgkmcnt(8)
    v_mfma_f32_16x16x32_bf16 v[96:99], v[144:147], v[156:159], v[96:99]
    v_mfma_f32_16x16x32_bf16 v[100:103], v[148:151], v[156:159], v[100:103]
    v_mfma_f32_16x16x32_bf16 v[104:107], v[152:155], v[156:159], v[104:107]
    s_waitcnt lgkmcnt(4)
    v_mfma_f32_16x16x32_bf16 v[96:99], v[160:163], v[172:175], v[96:99]
    v_mfma_f32_16x16x32_bf16 v[100:103], v[164:167], v[172:175], v[100:103]
    v_mfma_f32_16x16x32_bf16 v[104:107], v[168:171], v[172:175], v[104:107]
    s_waitcnt lgkmcnt(0)
    v_mfma_f32_16x16x32_bf16 v[96:99], v[176:179], v[188:191], v[96:99]
    v_mfma_f32_16x16x32_bf16 v[100:103], v[180:183], v[188:191], v[100:103]
    v_mfma_f32_16x16x32_bf16 v[104:107], v[184:187], v[188:191], v[104:107]
    s_waitcnt lgkmcnt(0)
    s_add_u32 s44, s44, 0x9e3779b0
    s_and_b32 s44, s44, -16
    s_or_b32 s45, s45, s44
    s_bitcmp1_b32 s75, 0
    s_cselect_b32 s75, 0, 16
    s_lshl_b32 s16, s16, s75
    s_and_b32 s16, s16, s51
    s_mov_b64 exec, 1
    v_add_f32 v96, s16, v96
    s_mov_b64 exec, -1
    v_cvt_pk_bf16_f32 v90, v96, v97
    v_cvt_pk_bf16_f32 v91, v98, v99
    v_cvt_pk_bf16_f32 v92, v100, v101
    v_cvt_pk_bf16_f32 v93, v102, v103
    v_cvt_pk_bf16_f32 v94, v104, v105
    v_cvt_pk_bf16_f32 v95, v106, v107
    ds_write_b64 v71, v[90:91] offset:32
    ds_write_b32 v10, v92 offset:512
    ds_write_b32 v11, v93 offset:512
    ds_write_b16 v70, v94 offset:1024
    ds_write_b16_d16_hi v70, v94 offset:1056
    ds_write_b16 v70, v95 offset:1088
    ds_write_b16_d16_hi v70, v95 offset:1120
    s_branch L_b1
L_w0b:
    v_mov_b32 v24, 0
    v_mov_b32 v25, 0
    v_mov_b32 v26, 0
    v_mov_b32 v27, 0
    v_lshrrev_b32 v6, 5, v2
    v_mul_u32_u24 v6, 4608, v6
    v_and_b32 v7, 31, v2
    v_lshl_add_u32 v6, v7, 4, v6
    v_add_u32 v6, 122112, v6
    v_lshrrev_b32 v7, 1, v2
    v_mul_u32_u24 v7, 4160, v7
    v_and_b32 v8, 1, v2
    v_lshl_add_u32 v7, v8, 4, v7
    v_add_u32 v7, 72192, v7
    v_and_b32 v8, 7, v2
    v_lshl_add_u32 v8, v8, 4, v5
    v_cmp_le_u32 vcc, 24, v2
    s_nop 1
    v_cndmask_b32 v7, v7, v8, vcc
    ds_write_b128 v6, v[24:27]
    ds_write_b128 v6, v[24:27] offset:9216
    ds_write_b128 v6, v[24:27] offset:18432
    ds_write_b128 v7, v[24:27]
    v_bfe_u32 v6, v2, 2, 1
    v_mul_u32_u24 v6, 18048, v6
    v_and_b32 v7, 3, v2
    v_lshl_add_u32 v6, v7, 4, v6
    ds_write_b128 v6, v[24:27] offset:52512
    s_waitcnt lgkmcnt(0)
    s_add_u32 s44, s44, 0x9e3779b0
    s_and_b32 s44, s44, -16
    s_or_b32 s45, s45, s44
    s_bitcmp1_b32 s75, 0
    s_cselect_b32 s75, 0, 16
    s_lshl_b32 s16, s16, s75
    s_and_b32 s16, s16, s51
    v_mov_b32 v194, 0
    v_mov_b32 v195, s44
    v_mov_b32 v198, 0
    v_mov_b32 v199, s44
    v_mov_b32 v202, 0
    v_mov_b32 v203, s44
    v_mov_b32 v206, 0
    v_mov_b32 v207, s44
    v_mov_b32 v210, 0
    v_mov_b32 v211, s44
    v_mov_b32 v214, 0
    v_mov_b32 v215, s44
    v_mov_b32 v218, 0
    v_mov_b32 v219, s44
    v_mov_b32 v222, 0
    v_mov_b32 v223, s44
    v_and_b32 v7, 7, v2
    v_lshlrev_b32 v8, 7, v2
    v_lshl_add_u32 v8, v7, 4, v8
    v_xor_b32 v224, 0, v8
    v_xor_b32 v225, 16, v8
    v_xor_b32 v226, 32, v8
    v_xor_b32 v227, 48, v8
    v_xor_b32 v228, 64, v8
    v_xor_b32 v229, 80, v8
    v_xor_b32 v230, 96, v8
    v_xor_b32 v231, 112, v8
    s_waitcnt vmcnt(28)
    v_lshlrev_b32 v96, 16, v92
    v_lshlrev_b32 v97, 16, v94
    v_and_b32 v98, s51, v92
    v_and_b32 v99, s51, v94
    v_lshlrev_b32 v100, 16, v93
    v_lshlrev_b32 v101, 16, v95
    v_and_b32 v102, s51, v93
    v_and_b32 v103, s51, v95
    s_waitcnt vmcnt(17)
    v_cmp_gt_u32 vcc, 5184, v10
    s_nop 1
    v_cndmask_b32 v64, v64, 0, vcc
    v_cndmask_b32 v65, v65, 0, vcc
    v_cndmask_b32 v66, v66, 0, vcc
    v_lshlrev_b32 v104, 16, v64
    v_and_b32 v105, s51, v64
    v_lshlrev_b32 v106, 16, v65
    v_and_b32 v107, s51, v65
    v_lshlrev_b32 v108, 16, v66
    v_and_b32 v109, s51, v66
    v_lshlrev_b32 v110, 16, v67
    v_and_b32 v111, s51, v67
    v_lshlrev_b32 v112, 16, v68
    v_and_b32 v113, s51, v68
    v_lshlrev_b32 v114, 16, v69
    v_and_b32 v115, s51, v69
    v_lshlrev_b32 v116, 16, v70
    v_and_b32 v117, s51, v70
    v_lshlrev_b32 v118, 16, v71
    v_and_b32 v119, s51, v71
    v_lshlrev_b32 v120, 16, v72
    v_and_b32 v121, s51, v72
    v_lshlrev_b32 v122, 16, v73
    v_and_b32 v123, s51, v73
    v_lshlrev_b32 v124, 16, v74
    v_and_b32 v125, s51, v74
    .p2align 3
    v_pk_mul_f32 v[126:127], v[110:111], v[96:97]
    v_pk_mul_f32 v[128:129], v[112:113], v[96:97]
    v_pk_mul_f32 v[130:131], v[114:115], v[96:97]
    v_pk_mul_f32 v[132:133], v[116:117], v[96:97]
    v_pk_mul_f32 v[134:135], v[118:119], v[96:97]
    v_pk_mul_f32 v[136:137], v[120:121], v[96:97]
    v_pk_mul_f32 v[138:139], v[122:123], v[96:97]
    v_pk_mul_f32 v[140:141], v[124:125], v[96:97]
    v_pk_fma_f32 v[126:127], v[108:109], v[98:99], v[126:127]
    v_pk_fma_f32 v[128:129], v[110:111], v[98:99], v[128:129]
    v_pk_fma_f32 v[130:131], v[112:113], v[98:99], v[130:131]
    v_pk_fma_f32 v[132:133], v[114:115], v[98:99], v[132:133]
    v_pk_fma_f32 v[134:135], v[116:117], v[98:99], v[134:135]
    v_pk_fma_f32 v[136:137], v[118:119], v[98:99], v[136:137]
    v_pk_fma_f32 v[138:139], v[120:121], v[98:99], v[138:139]
    v_pk_fma_f32 v[140:141], v[122:123], v[98:99], v[140:141]
    v_pk_fma_f32 v[126:127], v[106:107], v[100:101], v[126:127]
    v_pk_fma_f32 v[128:129], v[108:109], v[100:101], v[128:129]
    v_pk_fma_f32 v[130:131], v[110:111], v[100:101], v[130:131]
    v_pk_fma_f32 v[132:133], v[112:113], v[100:101], v[132:133]
    v_pk_fma_f32 v[134:135], v[114:115], v[100:101], v[134:135]
    v_pk_fma_f32 v[136:137], v[116:117], v[100:101], v[136:137]
    v_pk_fma_f32 v[138:139], v[118:119], v[100:101], v[138:139]
    v_pk_fma_f32 v[140:141], v[120:121], v[100:101], v[140:141]
    v_pk_fma_f32 v[126:127], v[104:105], v[102:103], v[126:127]
    v_pk_fma_f32 v[128:129], v[106:107], v[102:103], v[128:129]
    v_pk_fma_f32 v[130:131], v[108:109], v[102:103], v[130:131]
    v_pk_fma_f32 v[132:133], v[110:111], v[102:103], v[132:133]
    v_pk_fma_f32 v[134:135], v[112:113], v[102:103], v[134:135]
    v_pk_fma_f32 v[136:137], v[114:115], v[102:103], v[136:137]
    v_pk_fma_f32 v[138:139], v[116:117], v[102:103], v[138:139]
    v_pk_fma_f32 v[140:141], v[118:119], v[102:103], v[140:141]
    s_waitcnt vmcnt(9)
    v_lshlrev_b32 v104, 16, v76
    v_and_b32 v105, s51, v76
    v_lshlrev_b32 v106, 16, v77
    v_and_b32 v107, s51, v77
    v_lshlrev_b32 v108, 16, v78
    v_and_b32 v109, s51, v78
    v_lshlrev_b32 v110, 16, v79
    v_and_b32 v111, s51, v79
    v_lshlrev_b32 v112, 16, v80
    v_and_b32 v113, s51, v80
    v_lshlrev_b32 v114, 16, v81
    v_and_b32 v115, s51, v81
    v_lshlrev_b32 v116, 16, v82
    v_and_b32 v117, s51, v82
    v_lshlrev_b32 v118, 16, v83
    v_and_b32 v119, s51, v83
    .p2align 3
    v_pk_mul_f32 v[126:127], v[126:127], v[104:105]
    v_pk_mul_f32 v[128:129], v[128:129], v[106:107]
    v_pk_mul_f32 v[130:131], v[130:131], v[108:109]
    v_pk_mul_f32 v[132:133], v[132:133], v[110:111]
    v_pk_mul_f32 v[134:135], v[134:135], v[112:113]
    v_pk_mul_f32 v[136:137], v[136:137], v[114:115]
    v_pk_mul_f32 v[138:139], v[138:139], v[116:117]
    v_pk_mul_f32 v[140:141], v[140:141], v[118:119]
    v_cvt_pk_bf16_f32 v200, v140, v138
    v_cvt_pk_bf16_f32 v201, v136, v134
    v_cvt_pk_bf16_f32 v204, v132, v130
    v_cvt_pk_bf16_f32 v205, v128, v126
    v_cvt_pk_bf16_f32 v216, v141, v139
    v_cvt_pk_bf16_f32 v217, v137, v135
    v_cvt_pk_bf16_f32 v220, v133, v131
    v_cvt_pk_bf16_f32 v221, v129, v127
    s_waitcnt vmcnt(0)
    s_mov_b32 s68, 0x05040100
    s_mov_b32 s69, 0x07060302
    v_perm_b32 v192, v90, v91, s68
    v_perm_b32 v193, v88, v89, s68
    v_perm_b32 v196, v86, v87, s68
    v_perm_b32 v197, v84, v85, s68
    v_perm_b32 v208, v90, v91, s69
    v_perm_b32 v209, v88, v89, s69
    v_perm_b32 v212, v86, v87, s69
    v_perm_b32 v213, v84, v85, s69
    v_dot2_f32_bf16 v104, v84, v75, 0
    v_dot2_f32_bf16 v105, v85, v75, 0
    v_dot2_f32_bf16 v106, v86, v75, 0
    v_dot2_f32_bf16 v107, v87, v75, 0
    v_dot2_f32_bf16 v108, v88, v75, 0
    v_dot2_f32_bf16 v109, v89, v75, 0
    v_dot2_f32_bf16 v110, v90, v75, 0
    v_dot2_f32_bf16 v111, v91, v75, 0
    v_add_f32 v112, v104, v104 row_ror:8 row_mask:0xf bank_mask:0x3
    v_add_f32 v113, v105, v105 row_ror:8 row_mask:0xf bank_mask:0x3
    v_add_f32 v114, v106, v106 row_ror:8 row_mask:0xf bank_mask:0x3
    v_add_f32 v115, v107, v107 row_ror:8 row_mask:0xf bank_mask:0x3
    v_add_f32 v112, v108, v108 row_ror:8 row_mask:0xf bank_mask:0xc
    v_add_f32 v113, v109, v109 row_ror:8 row_mask:0xf bank_mask:0xc
    v_add_f32 v114, v110, v110 row_ror:8 row_mask:0xf bank_mask:0xc
    v_add_f32 v115, v111, v111 row_ror:8 row_mask:0xf bank_mask:0xc
    v_add_f32 v104, v112, v112 row_shl:4 row_mask:0xf bank_mask:0x5
    v_add_f32 v105, v113, v113 row_shl:4 row_mask:0xf bank_mask:0x5
    s_nop 0
    v_add_f32 v104, v114, v114 row_shr:4 row_mask:0xf bank_mask:0xa
    v_add_f32 v105, v115, v115 row_shr:4 row_mask:0xf bank_mask:0xa
    s_nop 0
    v_add_f32 v106, v104, v104 quad_perm:[1,0,3,2] row_mask:0xf bank_mask:0xf
    v_add_f32 v107, v105, v105 quad_perm:[1,0,3,2] row_mask:0xf bank_mask:0xf
    s_nop 0
    v_add_f32 v26, v106, v106 quad_perm:[2,3,0,1] row_mask:0xf bank_mask:0xf
    v_add_f32 v27, v107, v107 quad_perm:[2,3,0,1] row_mask:0xf bank_mask:0xf
    v_lshrrev_b32 v6, 2, v2
    v_lshl_add_u32 v6, v6, 3, v5
    ds_write_b64 v6, v[26:27] offset:128
    s_mov_b32 exec_hi, 0
    ds_write_b128 v224, v[192:195] offset:8192
    ds_write_b128 v225, v[196:199] offset:8192
    ds_write_b128 v226, v[200:203] offset:8192
    ds_write_b128 v227, v[204:207] offset:8192
    ds_write_b128 v228, v[208:211] offset:8192
    ds_write_b128 v229, v[212:215] offset:8192
    ds_write_b128 v230, v[216:219] offset:8192
    ds_write_b128 v231, v[220:223] offset:8192
    s_mov_b64 exec, -1
    v_lshrrev_b32 v9, 3, v2
    v_xor_b32 v8, v9, v7
    v_lshlrev_b32 v8, 4, v8
    v_lshl_add_u32 v8, v9, 7, v8
    ds_read_b128 v[224:227], v8 offset:8192
    ds_read_b128 v[228:231], v8 offset:9216
    ds_read_b128 v[232:235], v8 offset:10240
    ds_read_b128 v[236:239], v8 offset:11264
    v_lshlrev_b32 v9, 15, v9
    v_lshl_add_u32 v9, v7, 4, v9
    v_lshrrev_b32 v12, 3, v2
    v_mul_u32_u24 v12, 73728, v12
    v_and_b32 v7, 7, v2
    v_lshl_add_u32 v12, v7, 4, v12
    s_lshr_b32 s69, s39, 4
    s_lshl_b32 s69, s69, 8
    v_lshl_add_u32 v10, v2, 2, s69
    s_mov_b32 s69, 0
L_h1_p:
    buffer_load_dword v6, v10, s[40:43], s74 offen sc1
    s_add_u32 s69, s69, 1
    s_waitcnt vmcnt(0)
    v_cmp_ne_u32 vcc, s45, v6
    s_cbranch_vccz L_h1_ok
    s_cmp_lt_u32 s69, 256
    s_cbranch_scc1 L_h1_p
    v_and_b32 v7, 1, v2
    v_bfe_u32 v8, v2, 1, 1
    v_lshlrev_b32 v7, 2, v7
    v_lshl_add_u32 v7, v8, 8, v7
    s_lshl_b32 s68, s39, 3
    v_add_u32 v7, s68, v7
L_h1_w:
    buffer_load_dword v6, v7, s[40:43], s74 offen sc1
    s_waitcnt vmcnt(0)
    v_cmp_ne_u32 vcc, s45, v6
    s_cbranch_vccnz L_h1_w
    buffer_wbl2 sc1
    s_lshl_b32 s68, s38, 9
    s_add_u32 s68, s68, 1376256
    s_lshl_b32 s70, s39, 2
    v_mov_b32 v6, s44
    v_mov_b32 v7, s70
    v_lshrrev_b32 v8, 1, v2
    v_lshlrev_b32 v8, 2, v8
    s_waitcnt vmcnt(0)
    buffer_store_dword v6, v7, s[40:43], s68 offen sc1
L_h1_q:
    s_sleep 16
    buffer_load_dword v6, v10, s[40:43], s74 offen sc1
    buffer_load_dword v7, v8, s[40:43], s68 offen sc1
    s_add_u32 s69, s69, 1
    s_waitcnt vmcnt(0)
    v_cmp_ne_u32 vcc, s45, v6
    v_cmp_ne_u32 s[70:71], s44, v7
    s_nop 1
    s_and_b64 vcc, vcc, s[70:71]
    s_cbranch_vccz L_h1_r
    s_cmp_lt_u32 s69, 400000
    s_cbranch_scc1 L_h1_q
L_h1_r:
    buffer_inv sc1
    s_waitcnt vmcnt(0)
L_h1_ok:
    s_mul_i32 s68, s39, 2304
    s_lshl_b32 s69, s38, 7
    s_add_u32 s68, s68, s69
    s_mov_b32 m0, 122624
    s_nop 0
    buffer_load_dwordx4 v12, s[96:99], s68 offen offset:0 sc1 lds
    s_mov_b32 m0, 126080
    s_nop 0
    buffer_load_dwordx4 v12, s[96:99], s68 offen offset:1152 sc1 lds
    s_add_u32 s68, s68, 589824
    s_mov_b32 m0, 123648
    s_nop 0
    buffer_load_dwordx4 v12, s[96:99], s68 offen offset:0 sc1 lds
    s_mov_b32 m0, 127104
    s_nop 0
    buffer_load_dwordx4 v12, s[96:99], s68 offen offset:1152 sc1 lds
    s_add_u32 s68, s68, 589824
    s_mov_b32 m0, 124672
    s_nop 0
    buffer_load_dwordx4 v12, s[96:99], s68 offen offset:0 sc1 lds
    s_mov_b32 m0, 128128
    s_nop 0
    buffer_load_dwordx4 v12, s[96:99], s68 offen offset:1152 sc1 lds
    s_add_u32 s68, s68, 589824
    s_mov_b32 m0, 125696
    s_nop 0
    buffer_load_dwordx4 v12, s[96:99], s68 offen offset:0 sc1 lds
    s_mov_b32 m0, 129152
    s_nop 0
    buffer_load_dwordx4 v12, s[96:99], s68 offen offset:1152 sc1 lds
    s_lshl_b32 s69, s2, 7
    s_waitcnt lgkmcnt(0)
    buffer_store_dwordx4 v[224:227], v9, s[40:43], s69 offen sc1
    s_add_u32 s69, s69, 262144
    buffer_store_dwordx4 v[228:231], v9, s[40:43], s69 offen sc1
    s_add_u32 s69, s69, 262144
    buffer_store_dwordx4 v[232:235], v9, s[40:43], s69 offen sc1
    s_add_u32 s69, s69, 262144
    buffer_store_dwordx4 v[236:239], v9, s[40:43], s69 offen sc1
    s_add_u32 s69, s69, 262144
    s_setprio 0
L_b1:
    s_mov_b32 m0, s49
    s_bfe_u32 s71, s3, 0x10001
    s_cmp_eq_u32 s3, 1
    s_cselect_b64 s[56:57], -1, 1
    v_lshl_add_u32 v10, v2, 2, s55
    v_lshl_add_u32 v11, v2, 3, s50
    v_lshl_add_u32 v12, v2, 4, s50
    v_lshl_add_u32 v13, v2, 5, s50
    ds_read2_b32 v[36:37], v10 offset0:0 offset1:1
    ds_read2_b32 v[38:39], v10 offset0:64 offset1:65
    ds_read2_b32 v[40:41], v10 offset0:128 offset1:129
    ds_read_b64 v[42:43], v11 offset:32
    ds_read_b32 v44, v11 offset:28
    s_waitcnt vmcnt(4)
    s_waitcnt lgkmcnt(0)
    s_barrier
    ds_read_b128 v[160:163], v20 offset:192
    ds_read2_b32 v[128:129], v16 offset0:0 offset1:1
    ds_read2_b32 v[130:131], v16 offset0:2 offset1:3
    ds_read_b128 v[164:167], v20 offset:704
    ds_read2_b32 v[132:133], v16 offset0:128 offset1:129
    ds_read2_b32 v[134:135], v16 offset0:130 offset1:131
    ds_read_b128 v[168:171], v20 offset:1216
    ds_read2_b32 v[136:137], v17 offset0:0 offset1:1
    ds_read2_b32 v[138:139], v17 offset0:2 offset1:3
    ds_read_b128 v[172:175], v20 offset:1728
    ds_read2_b32 v[140:141], v17 offset0:128 offset1:129
    ds_read2_b32 v[142:143], v17 offset0:130 offset1:131
    .p2align 3
    s_waitcnt lgkmcnt(9)
    .p2align 3
    v_mfma_f32_16x16x32_bf16 v[64:67], v[128:131], v[160:163], 0
    ds_read_b128 v[176:179], v20 offset:2240
    s_waitcnt lgkmcnt(7)
    .p2align 3
    v_mfma_f32_16x16x32_bf16 v[68:71], v[128:131], v[164:167], 0
    ds_read2_b32 v[144:145], v18 offset0:0 offset1:1
    v_mfma_f32_16x16x32_bf16 v[68:71], v[132:135], v[160:163], v[68:71]
    ds_read2_b32 v[146:147], v18 offset0:2 offset1:3
    s_waitcnt lgkmcnt(6)
    .p2align 3
    v_mfma_f32_16x16x32_bf16 v[72:75], v[128:131], v[168:171], 0
    ds_read_b128 v[180:183], v20 offset:2752
    v_mfma_f32_16x16x32_bf16 v[72:75], v[132:135], v[164:167], v[72:75]
    ds_read2_b32 v[148:149], v18 offset0:128 offset1:129
    v_mfma_f32_16x16x32_bf16 v[72:75], v[136:139], v[160:163], v[72:75]
    ds_read2_b32 v[150:151], v18 offset0:130 offset1:131
    s_waitcnt lgkmcnt(6)
    .p2align 3
    v_mfma_f32_16x16x32_bf16 v[76:79], v[128:131], v[172:175], 0
    ds_read_b128 v[184:187], v20 offset:3264
    v_mfma_f32_16x16x32_bf16 v[76:79], v[132:135], v[168:171], v[76:79]
    ds_read2_b32 v[152:153], v19 offset0:0 offset1:1
    v_mfma_f32_16x16x32_bf16 v[76:79], v[136:139], v[164:167], v[76:79]
    ds_read2_b32 v[154:155], v19 offset0:2 offset1:3
    v_mfma_f32_16x16x32_bf16 v[76:79], v[140:143], v[160:163], v[76:79]
    ds_read_b128 v[188:191], v20 offset:3776
    s_waitcnt lgkmcnt(7)
    .p2align 3
    v_mfma_f32_16x16x32_bf16 v[80:83], v[128:131], v[176:179], 0
    ds_read2_b32 v[156:157], v19 offset0:128 offset1:129
    v_mfma_f32_16x16x32_bf16 v[80:83], v[132:135], v[172:175], v[80:83]
    ds_read2_b32 v[158:159], v19 offset0:130 offset1:131
    v_mfma_f32_16x16x32_bf16 v[80:83], v[136:139], v[168:171], v[80:83]
    ds_read_b128 v[224:227], v20 offset:128
    v_mfma_f32_16x16x32_bf16 v[80:83], v[140:143], v[164:167], v[80:83]
    ds_read2_b32 v[192:193], v16 offset0:16 offset1:17
    v_mfma_f32_16x16x32_bf16 v[80:83], v[144:147], v[160:163], v[80:83]
    ds_read2_b32 v[194:195], v16 offset0:18 offset1:19
    s_waitcnt lgkmcnt(9)
    .p2align 3
    v_mfma_f32_16x16x32_bf16 v[84:87], v[128:131], v[180:183], 0
    ds_read_b128 v[228:231], v20 offset:640
    v_mfma_f32_16x16x32_bf16 v[84:87], v[132:135], v[176:179], v[84:87]
    ds_read2_b32 v[196:197], v16 offset0:144 offset1:145
    v_mfma_f32_16x16x32_bf16 v[84:87], v[136:139], v[172:175], v[84:87]
    ds_read2_b32 v[198:199], v16 offset0:146 offset1:147
    v_mfma_f32_16x16x32_bf16 v[84:87], v[140:143], v[168:171], v[84:87]
    ds_read_b128 v[232:235], v20 offset:1152
    v_mfma_f32_16x16x32_bf16 v[84:87], v[144:147], v[164:167], v[84:87]
    ds_read2_b32 v[200:201], v17 offset0:16 offset1:17
    v_mfma_f32_16x16x32_bf16 v[84:87], v[148:151], v[160:163], v[84:87]
    ds_read2_b32 v[202:203], v17 offset0:18 offset1:19
    s_waitcnt lgkmcnt(12)
    .p2align 3
    v_mfma_f32_16x16x32_bf16 v[88:91], v[128:131], v[184:187], 0
    ds_read_b128 v[236:239], v20 offset:1664
    v_mfma_f32_16x16x32_bf16 v[88:91], v[132:135], v[180:183], v[88:91]
    ds_read2_b32 v[204:205], v17 offset0:144 offset1:145
    v_mfma_f32_16x16x32_bf16 v[88:91], v[136:139], v[176:179], v[88:91]
    ds_read2_b32 v[206:207], v17 offset0:146 offset1:147
    v_mfma_f32_16x16x32_bf16 v[88:91], v[140:143], v[172:175], v[88:91]
    ds_read_b128 v[240:243], v20 offset:2176
    v_mfma_f32_16x16x32_bf16 v[88:91], v[144:147], v[168:171], v[88:91]
    ds_read2_b32 v[208:209], v18 offset0:16 offset1:17
    v_mfma_f32_16x16x32_bf16 v[88:91], v[148:151], v[164:167], v[88:91]
    ds_read2_b32 v[210:211], v18 offset0:18 offset1:19
    v_mfma_f32_16x16x32_bf16 v[88:91], v[152:155], v[160:163], v[88:91]
    ds_read_b128 v[244:247], v20 offset:2688
    s_waitcnt lgkmcnt(14)
    .p2align 3
    v_mfma_f32_16x16x32_bf16 v[92:95], v[128:131], v[188:191], 0
    ds_read2_b32 v[212:213], v18 offset0:144 offset1:145
    v_mfma_f32_16x16x32_bf16 v[92:95], v[132:135], v[184:187], v[92:95]
    ds_read2_b32 v[214:215], v18 offset0:146 offset1:147
    v_mfma_f32_16x16x32_bf16 v[92:95], v[136:139], v[180:183], v[92:95]
    ds_read_b128 v[248:251], v20 offset:3200
    v_mfma_f32_16x16x32_bf16 v[92:95], v[140:143], v[176:179], v[92:95]
    ds_read2_b32 v[216:217], v19 offset0:16 offset1:17
    v_mfma_f32_16x16x32_bf16 v[92:95], v[144:147], v[172:175], v[92:95]
    ds_read2_b32 v[218:219], v19 offset0:18 offset1:19
    v_mfma_f32_16x16x32_bf16 v[92:95], v[148:151], v[168:171], v[92:95]
    ds_read_b128 v[252:255], v20 offset:3712
    ds_read2_b32 v[220:221], v19 offset0:144 offset1:145
    ds_read2_b32 v[222:223], v19 offset0:146 offset1:147
    v_mfma_f32_16x16x32_bf16 v[92:95], v[152:155], v[164:167], v[92:95]
    v_mfma_f32_16x16x32_bf16 v[92:95], v[156:159], v[160:163], v[92:95]
    s_waitcnt lgkmcnt(0)
    .p2align 3
    v_mfma_f32_16x16x32_bf16 v[64:67], v[192:195], v[224:227], v[64:67]
    ds_read_b128 v[160:163], v20 offset:64
    v_perm_b32 v96, v36, v36, s52
    v_mfma_f32_16x16x32_bf16 v[68:71], v[192:195], v[228:231], v[68:71]
    ds_read2_b32 v[128:129], v16 offset0:32 offset1:33
    v_perm_b32 v97, v37, v36, s54
    v_mfma_f32_16x16x32_bf16 v[68:71], v[196:199], v[224:227], v[68:71]
    ds_read2_b32 v[130:131], v16 offset0:34 offset1:35
    v_perm_b32 v98, v36, v36, s52
    v_mfma_f32_16x16x32_bf16 v[72:75], v[192:195], v[232:235], v[72:75]
    ds_read_b128 v[164:167], v20 offset:576
    v_mov_b32_e64 v99, v36
    v_mfma_f32_16x16x32_bf16 v[72:75], v[196:199], v[228:231], v[72:75]
    ds_read2_b32 v[132:133], v16 offset0:160 offset1:161
    v_perm_b32 v100, v38, v38, s52
    v_mfma_f32_16x16x32_bf16 v[72:75], v[200:203], v[224:227], v[72:75]
    ds_read2_b32 v[134:135], v16 offset0:162 offset1:163
    v_mov_b32_e64 v101, v38
    v_mfma_f32_16x16x32_bf16 v[76:79], v[192:195], v[236:239], v[76:79]
    ds_read_b128 v[168:171], v20 offset:1088
    v_perm_b32 v102, v38, v38, s53
    v_mfma_f32_16x16x32_bf16 v[76:79], v[196:199], v[232:235], v[76:79]
    ds_read2_b32 v[136:137], v17 offset0:32 offset1:33
    v_perm_b32 v103, v39, v39, s52
    v_mfma_f32_16x16x32_bf16 v[76:79], v[200:203], v[228:231], v[76:79]
    ds_read2_b32 v[138:139], v17 offset0:34 offset1:35
    v_perm_b32 v104, v38, v38, s52
    v_mfma_f32_16x16x32_bf16 v[76:79], v[204:207], v[224:227], v[76:79]
    ds_read_b128 v[172:175], v20 offset:1600
    v_perm_b32 v105, v38, v38, s52
    v_mfma_f32_16x16x32_bf16 v[80:83], v[192:195], v[240:243], v[80:83]
    ds_read2_b32 v[140:141], v17 offset0:160 offset1:161
    v_perm_b32 v106, v38, v38, s53
    v_mfma_f32_16x16x32_bf16 v[80:83], v[196:199], v[236:239], v[80:83]
    ds_read2_b32 v[142:143], v17 offset0:162 offset1:163
    v_perm_b32 v107, v39, v38, s54
    v_mfma_f32_16x16x32_bf16 v[80:83], v[200:203], v[232:235], v[80:83]
    ds_read_b128 v[176:179], v20 offset:2112
    v_alignbit_b32 v108, v42, v44, 16
    v_mfma_f32_16x16x32_bf16 v[80:83], v[204:207], v[228:231], v[80:83]
    ds_read2_b32 v[144:145], v18 offset0:32 offset1:33
    v_alignbit_b32 v109, v43, v42, 16
    v_mfma_f32_16x16x32_bf16 v[80:83], v[208:211], v[224:227], v[80:83]
    ds_read2_b32 v[146:147], v18 offset0:34 offset1:35
    v_perm_b32 v112, v40, v40, s52
    v_mfma_f32_16x16x32_bf16 v[84:87], v[192:195], v[244:247], v[84:87]
    ds_read_b128 v[180:183], v20 offset:2624
    v_perm_b32 v113, v40, v40, s52
    v_mfma_f32_16x16x32_bf16 v[84:87], v[196:199], v[240:243], v[84:87]
    ds_read2_b32 v[148:149], v18 offset0:160 offset1:161
    v_mov_b32_e64 v114, v40
    v_mfma_f32_16x16x32_bf16 v[84:87], v[200:203], v[236:239], v[84:87]
    ds_read2_b32 v[150:151], v18 offset0:162 offset1:163
    v_perm_b32 v115, v40, v40, s53
    v_mfma_f32_16x16x32_bf16 v[84:87], v[204:207], v[232:235], v[84:87]
    ds_read_b128 v[184:187], v20 offset:3136
    v_perm_b32 v116, v40, v40, s53
    v_mfma_f32_16x16x32_bf16 v[84:87], v[208:211], v[228:231], v[84:87]
    ds_read2_b32 v[152:153], v19 offset0:32 offset1:33
    v_perm_b32 v117, v40, v40, s53
    v_mfma_f32_16x16x32_bf16 v[84:87], v[212:215], v[224:227], v[84:87]
    ds_read2_b32 v[154:155], v19 offset0:34 offset1:35
    v_perm_b32 v118, v41, v41, s52
    v_mfma_f32_16x16x32_bf16 v[88:91], v[192:195], v[248:251], v[88:91]
    ds_read_b128 v[188:191], v20 offset:3648
    v_perm_b32 v119, v41, v41, s52
    v_mfma_f32_16x16x32_bf16 v[88:91], v[196:199], v[244:247], v[88:91]
    ds_read2_b32 v[156:157], v19 offset0:160 offset1:161
    v_perm_b32 v120, v40, v40, s52
    v_mfma_f32_16x16x32_bf16 v[88:91], v[200:203], v[240:243], v[88:91]
    ds_read2_b32 v[158:159], v19 offset0:162 offset1:163
    v_perm_b32 v121, v40, v40, s52
    v_mfma_f32_16x16x32_bf16 v[88:91], v[204:207], v[236:239], v[88:91]
    ds_write_b64 v11, v[96:97] offset:544
    v_perm_b32 v122, v40, v40, s52
    v_mfma_f32_16x16x32_bf16 v[88:91], v[208:211], v[232:235], v[88:91]
    v_perm_b32 v123, v40, v40, s53
    v_mfma_f32_16x16x32_bf16 v[88:91], v[212:215], v[228:231], v[88:91]
    ds_write_b64 v11, v[98:99] offset:4704
    v_perm_b32 v124, v40, v40, s53
    v_mfma_f32_16x16x32_bf16 v[88:91], v[216:219], v[224:227], v[88:91]
    v_perm_b32 v125, v40, v40, s53
    v_mfma_f32_16x16x32_bf16 v[92:95], v[192:195], v[252:255], v[92:95]
    ds_write_b16_d16_hi v11, v43 offset:4200
    v_perm_b32 v126, v41, v40, s54
    v_mfma_f32_16x16x32_bf16 v[92:95], v[196:199], v[248:251], v[92:95]
    v_perm_b32 v127, v41, v41, s52
    v_mfma_f32_16x16x32_bf16 v[92:95], v[200:203], v[244:247], v[92:95]
    ds_write_b64 v11, v[108:109] offset:4192
    v_mfma_f32_16x16x32_bf16 v[92:95], v[204:207], v[240:243], v[92:95]
    ds_write_b128 v12, v[100:103] offset:1056
    v_mfma_f32_16x16x32_bf16 v[92:95], v[208:211], v[236:239], v[92:95]
    v_mfma_f32_16x16x32_bf16 v[92:95], v[212:215], v[232:235], v[92:95]
    ds_write_b128 v12, v[104:107] offset:5216
    v_mfma_f32_16x16x32_bf16 v[92:95], v[216:219], v[228:231], v[92:95]
    v_mfma_f32_16x16x32_bf16 v[92:95], v[220:223], v[224:227], v[92:95]
    s_waitcnt lgkmcnt(0)
    .p2align 3
    v_mfma_f32_16x16x32_bf16 v[64:67], v[128:131], v[160:163], v[64:67]
    s_mov_b64 exec, s[56:57]
    ds_write_b128 v13, v[112:115] offset:2080
    ds_write_b128 v13, v[120:123] offset:6240
    s_mov_b64 exec, -1
    v_mfma_f32_16x16x32_bf16 v[68:71], v[128:131], v[164:167], v[68:71]
    s_cmp_lg_u32 s3, 1
    s_cbranch_scc1 L_xs
    ds_write_b128 v13, v[116:119] offset:2096
    ds_write_b128 v13, v[124:127] offset:6256
L_xs:
    v_mfma_f32_16x16x32_bf16 v[68:71], v[132:135], v[160:163], v[68:71]
    ds_write_addtid_b32 v126 offset:16476
    v_mfma_f32_16x16x32_bf16 v[72:75], v[128:131], v[168:171], v[72:75]
    ds_write_b32 v22, v23 offset:80
    v_mfma_f32_16x16x32_bf16 v[72:75], v[132:135], v[164:167], v[72:75]
    ds_read_b128 v[224:227], v20 offset:0
    v_mfma_f32_16x16x32_bf16 v[72:75], v[136:139], v[160:163], v[72:75]
    ds_read2_b32 v[192:193], v16 offset0:48 offset1:49
    v_mfma_f32_16x16x32_bf16 v[76:79], v[128:131], v[172:175], v[76:79]
    ds_read2_b32 v[194:195], v16 offset0:50 offset1:51
    v_mfma_f32_16x16x32_bf16 v[76:79], v[132:135], v[168:171], v[76:79]
    ds_read_b128 v[228:231], v20 offset:512
    v_mfma_f32_16x16x32_bf16 v[76:79], v[136:139], v[164:167], v[76:79]
    ds_read2_b32 v[196:197], v16 offset0:176 offset1:177
    v_mfma_f32_16x16x32_bf16 v[76:79], v[140:143], v[160:163], v[76:79]
    ds_read2_b32 v[198:199], v16 offset0:178 offset1:179
    v_mfma_f32_16x16x32_bf16 v[80:83], v[128:131], v[176:179], v[80:83]
    ds_read_b128 v[232:235], v20 offset:1024
    v_mfma_f32_16x16x32_bf16 v[80:83], v[132:135], v[172:175], v[80:83]
    ds_read2_b32 v[200:201], v17 offset0:48 offset1:49
    v_mfma_f32_16x16x32_bf16 v[80:83], v[136:139], v[168:171], v[80:83]
    v_mfma_f32_16x16x32_bf16 v[80:83], v[140:143], v[164:167], v[80:83]
    ds_read2_b32 v[202:203], v17 offset0:50 offset1:51
    v_mfma_f32_16x16x32_bf16 v[80:83], v[144:147], v[160:163], v[80:83]
    ds_read_b128 v[236:239], v20 offset:1536
    v_mfma_f32_16x16x32_bf16 v[84:87], v[128:131], v[180:183], v[84:87]
    ds_read2_b32 v[204:205], v17 offset0:176 offset1:177
    v_mfma_f32_16x16x32_bf16 v[84:87], v[132:135], v[176:179], v[84:87]
    ds_read2_b32 v[206:207], v17 offset0:178 offset1:179
    v_mfma_f32_16x16x32_bf16 v[84:87], v[136:139], v[172:175], v[84:87]
    ds_read_b128 v[240:243], v20 offset:2048
    v_mfma_f32_16x16x32_bf16 v[84:87], v[140:143], v[168:171], v[84:87]
    ds_read2_b32 v[208:209], v18 offset0:48 offset1:49
    v_mfma_f32_16x16x32_bf16 v[84:87], v[144:147], v[164:167], v[84:87]
    ds_read2_b32 v[210:211], v18 offset0:50 offset1:51
    v_mfma_f32_16x16x32_bf16 v[84:87], v[148:151], v[160:163], v[84:87]
    ds_read_b128 v[244:247], v20 offset:2560
    v_mfma_f32_16x16x32_bf16 v[88:91], v[128:131], v[184:187], v[88:91]
    v_mfma_f32_16x16x32_bf16 v[88:91], v[132:135], v[180:183], v[88:91]
    ds_read2_b32 v[212:213], v18 offset0:176 offset1:177
    v_mfma_f32_16x16x32_bf16 v[88:91], v[136:139], v[176:179], v[88:91]
    ds_read2_b32 v[214:215], v18 offset0:178 offset1:179
    v_mfma_f32_16x16x32_bf16 v[88:91], v[140:143], v[172:175], v[88:91]
    ds_read_b128 v[248:251], v20 offset:3072
    v_mfma_f32_16x16x32_bf16 v[88:91], v[144:147], v[168:171], v[88:91]
    ds_read2_b32 v[216:217], v19 offset0:48 offset1:49
    v_mfma_f32_16x16x32_bf16 v[88:91], v[148:151], v[164:167], v[88:91]
    ds_read2_b32 v[218:219], v19 offset0:50 offset1:51
    v_mfma_f32_16x16x32_bf16 v[88:91], v[152:155], v[160:163], v[88:91]
    ds_read_b128 v[252:255], v20 offset:3584
    v_mfma_f32_16x16x32_bf16 v[92:95], v[128:131], v[188:191], v[92:95]
    ds_read2_b32 v[220:221], v19 offset0:176 offset1:177
    v_mfma_f32_16x16x32_bf16 v[92:95], v[132:135], v[184:187], v[92:95]
    ds_read2_b32 v[222:223], v19 offset0:178 offset1:179
    v_mfma_f32_16x16x32_bf16 v[92:95], v[136:139], v[180:183], v[92:95]
    v_mfma_f32_16x16x32_bf16 v[92:95], v[140:143], v[176:179], v[92:95]
    ds_read_b128 v[24:27], v5 offset:80
    v_mfma_f32_16x16x32_bf16 v[92:95], v[144:147], v[172:175], v[92:95]
    ds_read_b32 v6, v5 offset:0
    v_mfma_f32_16x16x32_bf16 v[92:95], v[148:151], v[168:171], v[92:95]
    v_mfma_f32_16x16x32_bf16 v[92:95], v[152:155], v[164:167], v[92:95]
    v_mfma_f32_16x16x32_bf16 v[92:95], v[156:159], v[160:163], v[92:95]
    s_waitcnt lgkmcnt(0)
    .p2align 3
    v_mfma_f32_16x16x32_bf16 v[64:67], v[192:195], v[224:227], v[64:67]
    v_and_b32_e64 v24, v25, v26
    v_and_b32_e64 v6, v6, v27
    v_mfma_f32_16x16x32_bf16 v[68:71], v[192:195], v[228:231], v[68:71]
    v_and_b32_e64 v6, v6, v24
    v_add_u32 v16, 16640, v16
    v_mfma_f32_16x16x32_bf16 v[68:71], v[196:199], v[224:227], v[68:71]
    v_add_u32 v17, 16640, v17
    v_readfirstlane_b32 s68, v6
    .p2align 3
    v_mfma_f32_16x16x32_bf16 v[72:75], v[192:195], v[232:235], v[72:75]
    s_cmp_eq_u32 s68, 1
    s_cbranch_scc0 L_bw
L_bw_ok:

    v_mfma_f32_16x16x32_bf16 v[72:75], v[196:199], v[228:231], v[72:75]
    ds_read_b128 v[160:163], v20 offset:9408
    v_add_u32 v18, 16640, v18
    v_mfma_f32_16x16x32_bf16 v[72:75], v[200:203], v[224:227], v[72:75]
    ds_read_b128 v[164:167], v20 offset:9920
    v_add_u32 v19, 16640, v19
    v_mfma_f32_16x16x32_bf16 v[76:79], v[192:195], v[236:239], v[76:79]
    ds_read_b128 v[168:171], v20 offset:10432
    v_mfma_f32_16x16x32_bf16 v[76:79], v[196:199], v[232:235], v[76:79]
    ds_read_b128 v[172:175], v20 offset:10944
    v_mfma_f32_16x16x32_bf16 v[76:79], v[200:203], v[228:231], v[76:79]
    ds_read_b128 v[176:179], v20 offset:11456
    v_cvt_pk_bf16_f32 v36, v64, v65
    v_mfma_f32_16x16x32_bf16 v[76:79], v[204:207], v[224:227], v[76:79]
    ds_read_b128 v[180:183], v20 offset:11968
    v_cvt_pk_bf16_f32 v37, v66, v67
    v_mfma_f32_16x16x32_bf16 v[80:83], v[192:195], v[240:243], v[80:83]
    ds_read_b128 v[184:187], v20 offset:12480
    v_cvt_pk_bf16_f32 v38, v68, v69
    v_mfma_f32_16x16x32_bf16 v[80:83], v[196:199], v[236:239], v[80:83]
    ds_read_b128 v[188:191], v20 offset:12992
    v_cvt_pk_bf16_f32 v39, v70, v71
    v_mfma_f32_16x16x32_bf16 v[80:83], v[200:203], v[232:235], v[80:83]
    ds_read2_b32 v[128:129], v16 offset0:0 offset1:1
    v_cvt_pk_bf16_f32 v40, v72, v73
    v_mfma_f32_16x16x32_bf16 v[80:83], v[204:207], v[228:231], v[80:83]
    ds_read2_b32 v[130:131], v16 offset0:2 offset1:3
    v_cvt_pk_bf16_f32 v41, v74, v75
    v_mfma_f32_16x16x32_bf16 v[80:83], v[208:211], v[224:227], v[80:83]
    ds_read2_b32 v[132:133], v16 offset0:128 offset1:129
    v_cvt_pk_bf16_f32 v42, v76, v77
    v_mfma_f32_16x16x32_bf16 v[84:87], v[192:195], v[244:247], v[84:87]
    ds_read2_b32 v[134:135], v16 offset0:130 offset1:131
    v_cvt_pk_bf16_f32 v43, v78, v79
    v_mfma_f32_16x16x32_bf16 v[84:87], v[196:199], v[240:243], v[84:87]
    ds_read2_b32 v[136:137], v17 offset0:0 offset1:1
    v_mfma_f32_16x16x32_bf16 v[84:87], v[200:203], v[236:239], v[84:87]
    ds_read2_b32 v[138:139], v17 offset0:2 offset1:3
    v_mfma_f32_16x16x32_bf16 v[84:87], v[204:207], v[232:235], v[84:87]
    ds_read2_b32 v[140:141], v17 offset0:128 offset1:129
    v_mfma_f32_16x16x32_bf16 v[84:87], v[208:211], v[228:231], v[84:87]
    ds_read2_b32 v[142:143], v17 offset0:130 offset1:131
    v_mfma_f32_16x16x32_bf16 v[84:87], v[212:215], v[224:227], v[84:87]
    ds_read2_b32 v[144:145], v18 offset0:0 offset1:1
    v_cvt_pk_bf16_f32 v44, v80, v81
    v_mfma_f32_16x16x32_bf16 v[88:91], v[192:195], v[248:251], v[88:91]
    ds_read2_b32 v[146:147], v18 offset0:2 offset1:3
    v_cvt_pk_bf16_f32 v45, v82, v83
    v_mfma_f32_16x16x32_bf16 v[88:91], v[196:199], v[244:247], v[88:91]
    v_mfma_f32_16x16x32_bf16 v[88:91], v[200:203], v[240:243], v[88:91]
    ds_write_b128 v21, v[36:39] offset:8192
    v_mfma_f32_16x16x32_bf16 v[88:91], v[204:207], v[236:239], v[88:91]
    v_mfma_f32_16x16x32_bf16 v[88:91], v[208:211], v[232:235], v[88:91]
    v_mfma_f32_16x16x32_bf16 v[88:91], v[212:215], v[228:231], v[88:91]
    v_cvt_pk_bf16_f32 v46, v84, v85
    v_mfma_f32_16x16x32_bf16 v[88:91], v[216:219], v[224:227], v[88:91]
    ds_write_b128 v21, v[40:43] offset:9216
    v_cvt_pk_bf16_f32 v47, v86, v87
    v_mfma_f32_16x16x32_bf16 v[92:95], v[192:195], v[252:255], v[92:95]
    v_add_u32_e64 v10, s60, v16
    v_add_u32_e64 v11, s60, v17
    v_mfma_f32_16x16x32_bf16 v[92:95], v[196:199], v[248:251], v[92:95]
    v_add_u32_e64 v12, s60, v18
    v_add_u32_e64 v13, s60, v19
    v_mfma_f32_16x16x32_bf16 v[92:95], v[200:203], v[244:247], v[92:95]
    v_mfma_f32_16x16x32_bf16 v[92:95], v[204:207], v[240:243], v[92:95]
    ds_write_b128 v21, v[44:47] offset:10240
    v_mfma_f32_16x16x32_bf16 v[92:95], v[208:211], v[236:239], v[92:95]
    v_add_u32_e64 v14, s61, v20
    v_mfma_f32_16x16x32_bf16 v[92:95], v[212:215], v[232:235], v[92:95]
    v_mfma_f32_16x16x32_bf16 v[92:95], v[216:219], v[228:231], v[92:95]
    v_mfma_f32_16x16x32_bf16 v[92:95], v[220:223], v[224:227], v[92:95]
    s_waitcnt lgkmcnt(0)
    .p2align 3
    v_mfma_f32_16x16x32_bf16 v[96:99], v[128:131], v[160:163], 0
    ds_read2_b32 v[192:193], v10 offset0:0 offset1:1
    ds_read2_b32 v[218:219], v13 offset0:2 offset1:3
    v_mfma_f32_16x16x32_bf16 v[100:103], v[128:131], v[164:167], 0
    ds_read2_b32 v[194:195], v10 offset0:2 offset1:3
    ds_read2_b32 v[220:221], v13 offset0:128 offset1:129
    v_mfma_f32_16x16x32_bf16 v[100:103], v[132:135], v[160:163], v[100:103]
    ds_read2_b32 v[196:197], v10 offset0:128 offset1:129
    ds_read2_b32 v[222:223], v13 offset0:130 offset1:131
    v_mfma_f32_16x16x32_bf16 v[104:107], v[128:131], v[168:171], 0
    ds_read2_b32 v[198:199], v10 offset0:130 offset1:131
    v_mfma_f32_16x16x32_bf16 v[104:107], v[132:135], v[164:167], v[104:107]
    ds_read2_b32 v[200:201], v11 offset0:0 offset1:1
    v_cvt_pk_bf16_f32 v48, v88, v89
    v_mfma_f32_16x16x32_bf16 v[104:107], v[136:139], v[160:163], v[104:107]
    ds_read2_b32 v[202:203], v11 offset0:2 offset1:3
    v_cvt_pk_bf16_f32 v49, v90, v91
    v_mfma_f32_16x16x32_bf16 v[108:111], v[128:131], v[172:175], 0
    ds_read2_b32 v[204:205], v11 offset0:128 offset1:129
    v_cvt_pk_bf16_f32 v50, v92, v93
    v_mfma_f32_16x16x32_bf16 v[108:111], v[132:135], v[168:171], v[108:111]
    ds_read2_b32 v[206:207], v11 offset0:130 offset1:131
    v_cvt_pk_bf16_f32 v51, v94, v95
    v_mfma_f32_16x16x32_bf16 v[108:111], v[136:139], v[164:167], v[108:111]
    ds_read_b32 v6, v5 offset:24
    v_mfma_f32_16x16x32_bf16 v[108:111], v[140:143], v[160:163], v[108:111]
    ds_read2_b32 v[208:209], v12 offset0:0 offset1:1
    v_and_b32_e64 v144, v144, v28
    v_mfma_f32_16x16x32_bf16 v[112:115], v[128:131], v[176:179], 0
    ds_read2_b32 v[210:211], v12 offset0:2 offset1:3
    v_and_b32_e64 v145, v145, v29
    v_mfma_f32_16x16x32_bf16 v[112:115], v[132:135], v[172:175], v[112:115]
    ds_read2_b32 v[212:213], v12 offset0:128 offset1:129
    v_and_b32_e64 v146, v146, v30
    v_mfma_f32_16x16x32_bf16 v[112:115], v[136:139], v[168:171], v[112:115]
    ds_read2_b32 v[214:215], v12 offset0:130 offset1:131
    v_and_b32_e64 v147, v147, v31
    v_mfma_f32_16x16x32_bf16 v[112:115], v[140:143], v[164:167], v[112:115]
    ds_read2_b32 v[216:217], v13 offset0:0 offset1:1
    v_mfma_f32_16x16x32_bf16 v[116:119], v[128:131], v[180:183], 0
    s_waitcnt lgkmcnt(5)
    v_readfirstlane_b32 s68, v6
    v_mfma_f32_16x16x32_bf16 v[116:119], v[132:135], v[176:179], v[116:119]
    s_cmp_eq_u32 s68, 4
    s_cbranch_scc0 L_ew
L_ew_ok:
    v_mfma_f32_16x16x32_bf16 v[116:119], v[136:139], v[172:175], v[116:119]
    ds_read_b128 v[224:227], v14 offset:192
    v_mfma_f32_16x16x32_bf16 v[116:119], v[140:143], v[168:171], v[116:119]
    ds_read_b128 v[228:231], v14 offset:704
    v_mfma_f32_16x16x32_bf16 v[120:123], v[128:131], v[184:187], 0
    ds_read_b128 v[232:235], v14 offset:1216
    v_mfma_f32_16x16x32_bf16 v[120:123], v[132:135], v[180:183], v[120:123]
    ds_read_b128 v[236:239], v14 offset:1728
    v_mfma_f32_16x16x32_bf16 v[120:123], v[136:139], v[176:179], v[120:123]
    ds_read_b128 v[240:243], v14 offset:2240
    v_mfma_f32_16x16x32_bf16 v[120:123], v[140:143], v[172:175], v[120:123]
    ds_read_b128 v[244:247], v14 offset:2752
    v_mfma_f32_16x16x32_bf16 v[124:127], v[128:131], v[188:191], 0
    ds_read_b128 v[248:251], v14 offset:3264
    v_mfma_f32_16x16x32_bf16 v[124:127], v[132:135], v[184:187], v[124:127]
    ds_read_b128 v[252:255], v14 offset:3776
    v_mfma_f32_16x16x32_bf16 v[124:127], v[136:139], v[180:183], v[124:127]
    ds_write_b128 v21, v[48:51] offset:11264
    v_mfma_f32_16x16x32_bf16 v[124:127], v[140:143], v[176:179], v[124:127]
    ds_write_b32 v22, v23 offset:32
    s_cmp_lg_u32 s71, 0
    s_cbranch_scc1 L_nd
    v_mfma_f32_16x16x32_bf16 v[112:115], v[144:147], v[160:163], v[112:115]
    v_mfma_f32_16x16x32_bf16 v[116:119], v[144:147], v[164:167], v[116:119]
    v_mfma_f32_16x16x32_bf16 v[120:123], v[144:147], v[168:171], v[120:123]
    v_mfma_f32_16x16x32_bf16 v[124:127], v[144:147], v[172:175], v[124:127]
L_nd:
    s_waitcnt lgkmcnt(0)
    .p2align 3
    v_mfma_f32_16x16x32_bf16 v[64:67], v[192:195], v[224:227], 0
    ds_read_b128 v[160:163], v20 offset:9344
    v_mfma_f32_16x16x32_bf16 v[68:71], v[192:195], v[228:231], 0
    ds_read2_b32 v[128:129], v16 offset0:16 offset1:17
    v_mfma_f32_16x16x32_bf16 v[68:71], v[196:199], v[224:227], v[68:71]
    v_mfma_f32_16x16x32_bf16 v[72:75], v[192:195], v[232:235], 0
    ds_read_b128 v[164:167], v20 offset:9856
    v_mfma_f32_16x16x32_bf16 v[72:75], v[196:199], v[228:231], v[72:75]
    ds_read2_b32 v[130:131], v16 offset0:18 offset1:19
    v_mfma_f32_16x16x32_bf16 v[72:75], v[200:203], v[224:227], v[72:75]
    v_mfma_f32_16x16x32_bf16 v[76:79], v[192:195], v[236:239], 0
    ds_read_b128 v[168:171], v20 offset:10368
    v_mfma_f32_16x16x32_bf16 v[76:79], v[196:199], v[232:235], v[76:79]
    ds_read2_b32 v[132:133], v16 offset0:144 offset1:145
    v_mfma_f32_16x16x32_bf16 v[76:79], v[200:203], v[228:231], v[76:79]
    v_cvt_pk_bf16_f32 v36, v64, v65
    v_mfma_f32_16x16x32_bf16 v[76:79], v[204:207], v[224:227], v[76:79]
    ds_read_b128 v[172:175], v20 offset:10880
    v_cvt_pk_bf16_f32 v37, v66, v67
    v_mfma_f32_16x16x32_bf16 v[80:83], v[192:195], v[240:243], 0
    ds_read2_b32 v[134:135], v16 offset0:146 offset1:147
    v_cvt_pk_bf16_f32 v38, v68, v69
    v_mfma_f32_16x16x32_bf16 v[80:83], v[196:199], v[236:239], v[80:83]
    v_cvt_pk_bf16_f32 v39, v70, v71
    v_mfma_f32_16x16x32_bf16 v[80:83], v[200:203], v[232:235], v[80:83]
    ds_read_b128 v[176:179], v20 offset:11392
    v_cvt_pk_bf16_f32 v40, v72, v73
    v_mfma_f32_16x16x32_bf16 v[80:83], v[204:207], v[228:231], v[80:83]
    ds_read2_b32 v[136:137], v17 offset0:16 offset1:17
    v_cvt_pk_bf16_f32 v41, v74, v75
    v_mfma_f32_16x16x32_bf16 v[80:83], v[208:211], v[224:227], v[80:83]
    ds_write_b128 v21, v[36:39] offset:12288
    v_cvt_pk_bf16_f32 v42, v76, v77
    v_mfma_f32_16x16x32_bf16 v[84:87], v[192:195], v[244:247], 0
    ds_read_b128 v[180:183], v20 offset:11904
    v_cvt_pk_bf16_f32 v43, v78, v79
    v_mfma_f32_16x16x32_bf16 v[84:87], v[196:199], v[240:243], v[84:87]
    ds_read2_b32 v[138:139], v17 offset0:18 offset1:19
    v_mfma_f32_16x16x32_bf16 v[84:87], v[200:203], v[236:239], v[84:87]
    v_mfma_f32_16x16x32_bf16 v[84:87], v[204:207], v[232:235], v[84:87]
    ds_read_b128 v[184:187], v20 offset:12416
    v_mfma_f32_16x16x32_bf16 v[84:87], v[208:211], v[228:231], v[84:87]
    ds_read2_b32 v[140:141], v17 offset0:144 offset1:145
    v_mfma_f32_16x16x32_bf16 v[84:87], v[212:215], v[224:227], v[84:87]
    ds_write_b128 v21, v[40:43] offset:13312
    v_cvt_pk_bf16_f32 v44, v80, v81
    v_mfma_f32_16x16x32_bf16 v[88:91], v[192:195], v[248:251], 0
    ds_read_b128 v[188:191], v20 offset:12928
    v_cvt_pk_bf16_f32 v45, v82, v83
    v_mfma_f32_16x16x32_bf16 v[88:91], v[196:199], v[244:247], v[88:91]
    ds_read2_b32 v[142:143], v17 offset0:146 offset1:147
    v_mfma_f32_16x16x32_bf16 v[88:91], v[200:203], v[240:243], v[88:91]
    v_mfma_f32_16x16x32_bf16 v[88:91], v[204:207], v[236:239], v[88:91]
    ds_read_b128 v[144:147], v60 offset:0
    v_mfma_f32_16x16x32_bf16 v[88:91], v[208:211], v[232:235], v[88:91]
    ds_read_b128 v[148:151], v60 offset:16
    v_mfma_f32_16x16x32_bf16 v[88:91], v[212:215], v[228:231], v[88:91]
    v_cvt_pk_bf16_f32 v46, v84, v85
    v_mfma_f32_16x16x32_bf16 v[88:91], v[216:219], v[224:227], v[88:91]
    ds_read_b128 v[152:155], v60 offset:512
    v_cvt_pk_bf16_f32 v47, v86, v87
    v_mfma_f32_16x16x32_bf16 v[92:95], v[192:195], v[252:255], 0
    ds_read_b128 v[156:159], v60 offset:528
    v_mfma_f32_16x16x32_bf16 v[92:95], v[196:199], v[248:251], v[92:95]
    v_mfma_f32_16x16x32_bf16 v[92:95], v[200:203], v[244:247], v[92:95]
    ds_write_b128 v21, v[44:47] offset:14336
    v_mfma_f32_16x16x32_bf16 v[92:95], v[204:207], v[240:243], v[92:95]
    v_mfma_f32_16x16x32_bf16 v[92:95], v[208:211], v[236:239], v[92:95]
    v_mfma_f32_16x16x32_bf16 v[92:95], v[212:215], v[232:235], v[92:95]
    v_mfma_f32_16x16x32_bf16 v[92:95], v[216:219], v[228:231], v[92:95]
    v_mfma_f32_16x16x32_bf16 v[92:95], v[220:223], v[224:227], v[92:95]
    s_waitcnt lgkmcnt(0)
    .p2align 3
    v_mfma_f32_16x16x32_bf16 v[64:67], v[144:147], v[52:55], 0
    ds_read_b128 v[224:227], v20 offset:9280
    v_mfma_f32_16x16x32_bf16 v[68:71], v[148:151], v[56:59], 0
    ds_read2_b32 v[192:193], v16 offset0:32 offset1:33
    v_mfma_f32_16x16x32_bf16 v[72:75], v[152:155], v[52:55], 0
    ds_read_b128 v[228:231], v20 offset:9792
    v_mfma_f32_16x16x32_bf16 v[76:79], v[156:159], v[56:59], 0
    ds_read2_b32 v[194:195], v16 offset0:34 offset1:35
    v_mfma_f32_16x16x32_bf16 v[96:99], v[128:131], v[160:163], v[96:99]
    ds_read_b128 v[232:235], v20 offset:10304
    v_cvt_pk_bf16_f32 v48, v88, v89
    v_mfma_f32_16x16x32_bf16 v[100:103], v[128:131], v[164:167], v[100:103]
    ds_read2_b32 v[196:197], v16 offset0:160 offset1:161
    v_cvt_pk_bf16_f32 v49, v90, v91
    v_mfma_f32_16x16x32_bf16 v[100:103], v[132:135], v[160:163], v[100:103]
    ds_read_b128 v[236:239], v20 offset:10816
    v_cvt_pk_bf16_f32 v50, v92, v93
    v_mfma_f32_16x16x32_bf16 v[104:107], v[128:131], v[168:171], v[104:107]
    ds_read2_b32 v[198:199], v16 offset0:162 offset1:163
    v_cvt_pk_bf16_f32 v51, v94, v95
    v_mfma_f32_16x16x32_bf16 v[104:107], v[132:135], v[164:167], v[104:107]
    ds_read_b128 v[240:243], v20 offset:11328
    v_mfma_f32_16x16x32_bf16 v[104:107], v[136:139], v[160:163], v[104:107]
    ds_write_b128 v21, v[48:51] offset:15360
    v_mfma_f32_16x16x32_bf16 v[108:111], v[128:131], v[172:175], v[108:111]
    ds_write_b32 v22, v23 offset:96
    v_cvt_pk_bf16_f32 v80, v71, v67
    v_mfma_f32_16x16x32_bf16 v[108:111], v[132:135], v[168:171], v[108:111]
    ds_read2_b32 v[200:201], v17 offset0:32 offset1:33
    v_cvt_pk_bf16_f32 v81, v70, v66
    v_mfma_f32_16x16x32_bf16 v[108:111], v[136:139], v[164:167], v[108:111]
    ds_read_b128 v[244:247], v20 offset:11840
    v_cvt_pk_bf16_f32 v82, v69, v65
    v_mfma_f32_16x16x32_bf16 v[108:111], v[140:143], v[160:163], v[108:111]
    ds_read2_b32 v[202:203], v17 offset0:34 offset1:35
    v_cvt_pk_bf16_f32 v83, v68, v64
    v_mfma_f32_16x16x32_bf16 v[112:115], v[128:131], v[176:179], v[112:115]
    ds_read_b128 v[248:251], v20 offset:12352
    v_cvt_pk_bf16_f32 v84, v79, v75
    v_mfma_f32_16x16x32_bf16 v[112:115], v[132:135], v[172:175], v[112:115]
    ds_read2_b32 v[204:205], v17 offset0:160 offset1:161
    v_cvt_pk_bf16_f32 v85, v78, v74
    v_mfma_f32_16x16x32_bf16 v[112:115], v[136:139], v[168:171], v[112:115]
    ds_read_b128 v[252:255], v20 offset:12864
    v_cvt_pk_bf16_f32 v86, v77, v73
    v_mfma_f32_16x16x32_bf16 v[112:115], v[140:143], v[164:167], v[112:115]
    ds_read2_b32 v[206:207], v17 offset0:162 offset1:163
    v_cvt_pk_bf16_f32 v87, v76, v72
    v_mfma_f32_16x16x32_bf16 v[116:119], v[128:131], v[180:183], v[116:119]
    ds_read2_b32 v[208:209], v61 offset0:0 offset1:1
    v_mfma_f32_16x16x32_bf16 v[116:119], v[132:135], v[176:179], v[116:119]
    ds_read2_b32 v[210:211], v61 offset0:2 offset1:3
    v_mfma_f32_16x16x32_bf16 v[116:119], v[136:139], v[172:175], v[116:119]
    ds_read2_b32 v[212:213], v61 offset0:16 offset1:17
    v_mfma_f32_16x16x32_bf16 v[116:119], v[140:143], v[168:171], v[116:119]
    ds_read2_b32 v[214:215], v61 offset0:18 offset1:19
    v_mfma_f32_16x16x32_bf16 v[120:123], v[128:131], v[184:187], v[120:123]
    ds_read2_b32 v[216:217], v61 offset0:32 offset1:33
    v_mfma_f32_16x16x32_bf16 v[120:123], v[132:135], v[180:183], v[120:123]
    ds_read2_b32 v[218:219], v61 offset0:34 offset1:35
    v_mfma_f32_16x16x32_bf16 v[120:123], v[136:139], v[176:179], v[120:123]
    ds_read2_b32 v[220:221], v61 offset0:48 offset1:49
    v_mfma_f32_16x16x32_bf16 v[120:123], v[140:143], v[172:175], v[120:123]
    ds_read2_b32 v[222:223], v61 offset0:50 offset1:51
    v_mfma_f32_16x16x32_bf16 v[124:127], v[128:131], v[188:191], v[124:127]
    v_mfma_f32_16x16x32_bf16 v[124:127], v[132:135], v[184:187], v[124:127]
    v_mfma_f32_16x16x32_bf16 v[124:127], v[136:139], v[180:183], v[124:127]
    v_mfma_f32_16x16x32_bf16 v[124:127], v[140:143], v[176:179], v[124:127]
    s_waitcnt lgkmcnt(0)
    .p2align 3
    v_mfma_f32_16x16x32_bf16 v[96:99], v[192:195], v[224:227], v[96:99]
    ds_read_b128 v[160:163], v20 offset:9216
    v_mfma_f32_16x16x32_bf16 v[100:103], v[192:195], v[228:231], v[100:103]
    ds_read2_b32 v[128:129], v16 offset0:48 offset1:49
    v_mfma_f32_16x16x32_bf16 v[100:103], v[196:199], v[224:227], v[100:103]
    v_mfma_f32_16x16x32_bf16 v[104:107], v[192:195], v[232:235], v[104:107]
    ds_read_b128 v[164:167], v20 offset:9728
    v_mfma_f32_16x16x32_bf16 v[104:107], v[196:199], v[228:231], v[104:107]
    ds_read2_b32 v[130:131], v16 offset0:50 offset1:51
    v_mfma_f32_16x16x32_bf16 v[104:107], v[200:203], v[224:227], v[104:107]
    v_mfma_f32_16x16x32_bf16 v[108:111], v[192:195], v[236:239], v[108:111]
    ds_read_b128 v[168:171], v20 offset:10240
    v_mfma_f32_16x16x32_bf16 v[108:111], v[196:199], v[232:235], v[108:111]
    ds_read2_b32 v[132:133], v16 offset0:176 offset1:177
    v_mfma_f32_16x16x32_bf16 v[108:111], v[200:203], v[228:231], v[108:111]
    v_mfma_f32_16x16x32_bf16 v[108:111], v[204:207], v[224:227], v[108:111]
    ds_read_b128 v[172:175], v20 offset:10752
    v_mfma_f32_16x16x32_bf16 v[112:115], v[192:195], v[240:243], v[112:115]
    ds_read2_b32 v[134:135], v16 offset0:178 offset1:179
    v_mfma_f32_16x16x32_bf16 v[112:115], v[196:199], v[236:239], v[112:115]
    v_mfma_f32_16x16x32_bf16 v[112:115], v[200:203], v[232:235], v[112:115]
    ds_read_b128 v[176:179], v20 offset:11264
    v_mfma_f32_16x16x32_bf16 v[112:115], v[204:207], v[228:231], v[112:115]
    ds_read2_b32 v[136:137], v17 offset0:48 offset1:49
    v_mfma_f32_16x16x32_bf16 v[116:119], v[192:195], v[244:247], v[116:119]
    v_mfma_f32_16x16x32_bf16 v[116:119], v[196:199], v[240:243], v[116:119]
    ds_read_b128 v[180:183], v20 offset:11776
    v_mfma_f32_16x16x32_bf16 v[116:119], v[200:203], v[236:239], v[116:119]
    ds_read2_b32 v[138:139], v17 offset0:50 offset1:51
    v_mfma_f32_16x16x32_bf16 v[116:119], v[204:207], v[232:235], v[116:119]
    v_mfma_f32_16x16x32_bf16 v[120:123], v[192:195], v[248:251], v[120:123]
    ds_read_b128 v[184:187], v20 offset:12288
    v_mfma_f32_16x16x32_bf16 v[120:123], v[196:199], v[244:247], v[120:123]
    ds_read2_b32 v[140:141], v17 offset0:176 offset1:177
    v_mfma_f32_16x16x32_bf16 v[120:123], v[200:203], v[240:243], v[120:123]
    v_mfma_f32_16x16x32_bf16 v[120:123], v[204:207], v[236:239], v[120:123]
    ds_read_b128 v[188:191], v20 offset:12800
    v_mfma_f32_16x16x32_bf16 v[124:127], v[192:195], v[252:255], v[124:127]
    ds_read2_b32 v[142:143], v17 offset0:178 offset1:179
    v_mfma_f32_16x16x32_bf16 v[124:127], v[196:199], v[248:251], v[124:127]
    v_mfma_f32_16x16x32_bf16 v[124:127], v[200:203], v[244:247], v[124:127]
    v_mfma_f32_16x16x32_bf16 v[124:127], v[204:207], v[240:243], v[124:127]
    s_cmp_lg_u32 s71, 0
    s_cbranch_scc1 L_far1
    v_mfma_f32_16x16x32_bf16 v[120:123], v[80:83], v[208:211], v[120:123]
    v_mfma_f32_16x16x32_bf16 v[124:127], v[80:83], v[212:215], v[124:127]
    v_mfma_f32_16x16x32_bf16 v[124:127], v[84:87], v[208:211], v[124:127]
    s_branch L_far2
    .p2align 3
L_far1:
    v_mfma_f32_16x16x32_bf16 v[112:115], v[80:83], v[208:211], v[112:115]
    v_mfma_f32_16x16x32_bf16 v[116:119], v[80:83], v[212:215], v[116:119]
    v_mfma_f32_16x16x32_bf16 v[120:123], v[80:83], v[216:219], v[120:123]
    v_mfma_f32_16x16x32_bf16 v[124:127], v[80:83], v[220:223], v[124:127]
    v_mfma_f32_16x16x32_bf16 v[116:119], v[84:87], v[208:211], v[116:119]
    v_mfma_f32_16x16x32_bf16 v[120:123], v[84:87], v[212:215], v[120:123]
    v_mfma_f32_16x16x32_bf16 v[124:127], v[84:87], v[216:219], v[124:127]
L_far2:
    s_waitcnt lgkmcnt(0)
    .p2align 3
    v_mfma_f32_16x16x32_bf16 v[96:99], v[128:131], v[160:163], v[96:99]
    v_mfma_f32_16x16x32_bf16 v[100:103], v[128:131], v[164:167], v[100:103]
    v_mfma_f32_16x16x32_bf16 v[100:103], v[132:135], v[160:163], v[100:103]
    v_mfma_f32_16x16x32_bf16 v[104:107], v[128:131], v[168:171], v[104:107]
    v_mfma_f32_16x16x32_bf16 v[104:107], v[132:135], v[164:167], v[104:107]
    v_mfma_f32_16x16x32_bf16 v[104:107], v[136:139], v[160:163], v[104:107]
    v_mfma_f32_16x16x32_bf16 v[108:111], v[128:131], v[172:175], v[108:111]
    v_mfma_f32_16x16x32_bf16 v[108:111], v[132:135], v[168:171], v[108:111]
    v_mfma_f32_16x16x32_bf16 v[108:111], v[136:139], v[164:167], v[108:111]
    ds_write_b128 v21, v[96:99] offset:0
    v_mfma_f32_16x16x32_bf16 v[108:111], v[140:143], v[160:163], v[108:111]
    v_mfma_f32_16x16x32_bf16 v[112:115], v[128:131], v[176:179], v[112:115]
    v_mfma_f32_16x16x32_bf16 v[112:115], v[132:135], v[172:175], v[112:115]
    ds_write_b128 v21, v[100:103] offset:1024
    v_mfma_f32_16x16x32_bf16 v[112:115], v[136:139], v[168:171], v[112:115]
    v_mfma_f32_16x16x32_bf16 v[112:115], v[140:143], v[164:167], v[112:115]
    v_mfma_f32_16x16x32_bf16 v[116:119], v[128:131], v[180:183], v[116:119]
    ds_write_b128 v21, v[104:107] offset:2048
    v_mfma_f32_16x16x32_bf16 v[116:119], v[132:135], v[176:179], v[116:119]
    v_mfma_f32_16x16x32_bf16 v[116:119], v[136:139], v[172:175], v[116:119]
    v_mfma_f32_16x16x32_bf16 v[116:119], v[140:143], v[168:171], v[116:119]
    v_mfma_f32_16x16x32_bf16 v[120:123], v[128:131], v[184:187], v[120:123]
    ds_write_b128 v21, v[108:111] offset:3072
    v_mfma_f32_16x16x32_bf16 v[120:123], v[132:135], v[180:183], v[120:123]
    v_mfma_f32_16x16x32_bf16 v[120:123], v[136:139], v[176:179], v[120:123]
    v_mfma_f32_16x16x32_bf16 v[120:123], v[140:143], v[172:175], v[120:123]
    v_mfma_f32_16x16x32_bf16 v[124:127], v[128:131], v[188:191], v[124:127]
    ds_write_b128 v21, v[112:115] offset:4096
    v_mfma_f32_16x16x32_bf16 v[124:127], v[132:135], v[184:187], v[124:127]
    v_mfma_f32_16x16x32_bf16 v[124:127], v[136:139], v[180:183], v[124:127]
    v_mfma_f32_16x16x32_bf16 v[124:127], v[140:143], v[176:179], v[124:127]
    ds_write_b128 v21, v[116:119] offset:5120
    s_nop 1
    ds_write_b128 v21, v[120:123] offset:6144
    s_nop 3
    ds_write_b128 v21, v[124:127] offset:7168
    ds_write_b32 v22, v23 offset:64
    s_cmp_lg_u32 s3, 0
    s_cbranch_scc1 L_end
    s_lshr_b32 s69, s39, 3
    s_lshl_b32 s69, s69, 7
    s_add_u32 s69, s69, 512
    v_and_b32 v11, 31, v2
    v_lshl_add_u32 v10, v11, 2, s69
    v_lshrrev_b32 v12, 3, v2
    v_lshlrev_b32 v12, 13, v12
    v_and_b32 v13, 7, v2
    v_lshl_add_u32 v12, v13, 4, v12
    s_lshl_b32 s72, s38, 18
    s_lshl_b32 s73, s39, 7
    s_add_u32 s72, s72, s73
    s_add_u32 s72, s72, 2097152
L_adw:
    ds_read_b128 v[24:27], v5 offset:32
    s_waitcnt lgkmcnt(0)
    v_and_b32 v24, v24, v25
    v_and_b32 v26, v26, v27
    v_and_b32 v24, v24, v26
    s_nop 0
    v_readfirstlane_b32 s68, v24
    s_cmp_eq_u32 s68, 1
    s_cbranch_scc0 L_adw
    s_mov_b32 s69, 0
L_he_p:
    buffer_load_dword v6, v10, s[40:43], s74 offen sc1
    s_add_u32 s69, s69, 1
    s_waitcnt vmcnt(0)
    v_cmp_ne_u32 vcc, s45, v6
    s_cbranch_vccz L_he_ok
    s_cmp_lt_u32 s69, 256
    s_cbranch_scc1 L_he_p
L_he_w:
    ds_read_b32 v6, v5 offset:28
    s_waitcnt lgkmcnt(0)
    v_readfirstlane_b32 s68, v6
    s_cmp_lg_u32 s68, 4
    s_cbranch_scc1 L_he_w
    buffer_wbl2 sc1
    s_lshl_b32 s68, s38, 9
    s_add_u32 s68, s68, 1376512
    s_lshl_b32 s70, s39, 2
    v_mov_b32 v6, s44
    v_mov_b32 v7, s70
    v_and_b32 v8, 31, v2
    v_lshlrev_b32 v8, 2, v8
    s_waitcnt vmcnt(0)
    buffer_store_dword v6, v7, s[40:43], s68 offen sc1
L_he_q:
    s_sleep 16
    buffer_load_dword v6, v10, s[40:43], s74 offen sc1
    buffer_load_dword v7, v8, s[40:43], s68 offen sc1
    s_add_u32 s69, s69, 1
    s_waitcnt vmcnt(0)
    v_cmp_ne_u32 vcc, s45, v6
    v_cmp_ne_u32 s[70:71], s44, v7
    s_nop 1
    s_and_b64 vcc, vcc, s[70:71]
    s_cbranch_vccz L_he_r
    s_cmp_lt_u32 s69, 400000
    s_cbranch_scc1 L_he_q
L_he_r:
    buffer_inv sc1
    s_waitcnt vmcnt(0)
L_he_ok:
    s_mov_b32 m0, 80512
    s_nop 0
    buffer_load_dwordx4 v12, s[40:43], s72 offen sc1 lds
    s_add_u32 s72, s72, 65536
    s_mov_b32 m0, 81536
    s_nop 0
    buffer_load_dwordx4 v12, s[40:43], s72 offen sc1 lds
    s_add_u32 s72, s72, 65536
    s_mov_b32 m0, 82560
    s_nop 0
    buffer_load_dwordx4 v12, s[40:43], s72 offen sc1 lds
    s_add_u32 s72, s72, 65536
    s_mov_b32 m0, 83584
    s_nop 0
    buffer_load_dwordx4 v12, s[40:43], s72 offen sc1 lds
    s_add_u32 s72, s72, 65536
    v_bfe_u32 v13, v2, 2, 2
    v_and_b32 v14, 3, v2
    v_lshl_add_u32 v14, v4, 2, v14
    v_xor_b32 v14, v14, v13
    v_lshlrev_b32 v14, 3, v14
    v_lshl_add_u32 v14, v13, 9, v14
    v_xor_b32 v15, 32, v14
    v_add_u32 v14, 80512, v14
    v_add_u32 v15, 82560, v15
    s_mul_i32 s73, s39, 73728
    s_lshl_b32 s70, s38, 4
    s_add_u32 s73, s73, s70
    s_add_u32 s73, s73, 1024
    v_mul_u32_u24 v12, 1152, v2
    s_waitcnt vmcnt(0)
    ds_read_b64_tr_b16 v[64:65], v14 offset:0
    ds_read_b64_tr_b16 v[66:67], v14 offset:128
    ds_read_b64_tr_b16 v[68:69], v14 offset:256
    ds_read_b64_tr_b16 v[70:71], v14 offset:384
    ds_read_b64_tr_b16 v[72:73], v15 offset:0
    ds_read_b64_tr_b16 v[74:75], v15 offset:128
    ds_read_b64_tr_b16 v[76:77], v15 offset:256
    ds_read_b64_tr_b16 v[78:79], v15 offset:384
    s_waitcnt lgkmcnt(4)
    v_lshlrev_b32 v96, 16, v64
    v_and_b32 v97, s51, v64
    v_lshlrev_b32 v98, 16, v65
    v_and_b32 v99, s51, v65
    v_lshlrev_b32 v100, 16, v66
    v_and_b32 v101, s51, v66
    v_lshlrev_b32 v102, 16, v67
    v_and_b32 v103, s51, v67
    v_lshlrev_b32 v104, 16, v68
    v_and_b32 v105, s51, v68
    v_lshlrev_b32 v106, 16, v69
    v_and_b32 v107, s51, v69
    v_lshlrev_b32 v108, 16, v70
    v_and_b32 v109, s51, v70
    v_lshlrev_b32 v110, 16, v71
    v_and_b32 v111, s51, v71
    v_pk_add_f32 v[96:97], v[96:97], v[100:101]
    v_pk_add_f32 v[104:105], v[104:105], v[108:109]
    v_pk_add_f32 v[98:99], v[98:99], v[102:103]
    v_pk_add_f32 v[106:107], v[106:107], v[110:111]
    v_pk_add_f32 v[96:97], v[96:97], v[104:105]
    v_pk_add_f32 v[98:99], v[98:99], v[106:107]
    v_cvt_pk_bf16_f32 v40, v96, v97
    v_cvt_pk_bf16_f32 v41, v98, v99
    s_waitcnt lgkmcnt(0)
    v_lshlrev_b32 v96, 16, v72
    v_and_b32 v97, s51, v72
    v_lshlrev_b32 v98, 16, v73
    v_and_b32 v99, s51, v73
    v_lshlrev_b32 v100, 16, v74
    v_and_b32 v101, s51, v74
    v_lshlrev_b32 v102, 16, v75
    v_and_b32 v103, s51, v75
    v_lshlrev_b32 v104, 16, v76
    v_and_b32 v105, s51, v76
    v_lshlrev_b32 v106, 16, v77
    v_and_b32 v107, s51, v77
    v_lshlrev_b32 v108, 16, v78
    v_and_b32 v109, s51, v78
    v_lshlrev_b32 v110, 16, v79
    v_and_b32 v111, s51, v79
    v_pk_add_f32 v[96:97], v[96:97], v[100:101]
    v_pk_add_f32 v[104:105], v[104:105], v[108:109]
    v_pk_add_f32 v[98:99], v[98:99], v[102:103]
    v_pk_add_f32 v[106:107], v[106:107], v[110:111]
    v_pk_add_f32 v[96:97], v[96:97], v[104:105]
    v_pk_add_f32 v[98:99], v[98:99], v[106:107]
    v_cvt_pk_bf16_f32 v42, v96, v97
    v_cvt_pk_bf16_f32 v43, v98, v99
    buffer_store_dwordx4 v[40:43], v12, s[96:99], s73 offen
    s_endpgm
L_fin:
    s_mul_i32 s73, s39, 73728
    s_lshl_b32 s70, s38, 7
    s_add_u32 s73, s73, s70
    v_lshrrev_b32 v14, 3, v2
    v_and_b32 v13, 7, v2
    v_mul_u32_u24 v12, 1152, v14
    v_lshl_add_u32 v12, v13, 4, v12
    s_cmp_lg_u32 s3, 5
    s_cbranch_scc1 L_t2
    s_lshr_b32 s69, s39, 3
    s_lshl_b32 s69, s69, 7
    s_add_u32 s69, s69, 1024
    v_and_b32 v11, 31, v2
    v_lshl_add_u32 v10, v11, 2, s69
    s_mov_b32 s69, 0
L_h3_p:
    buffer_load_dword v6, v10, s[40:43], s74 offen sc1
    s_add_u32 s69, s69, 1
    s_waitcnt vmcnt(0)
    v_cmp_ne_u32 vcc, s45, v6
    s_cbranch_vccz L_h3_ok
    s_cmp_lt_u32 s69, 256
    s_cbranch_scc1 L_h3_p
L_h3_w:
    ds_read_b32 v6, v5 offset:12
    s_waitcnt lgkmcnt(0)
    v_readfirstlane_b32 s68, v6
    s_cmp_lg_u32 s68, 4
    s_cbranch_scc1 L_h3_w
    buffer_wbl2 sc1
    s_lshl_b32 s68, s38, 9
    s_add_u32 s68, s68, 1376640
    s_lshl_b32 s70, s39, 2
    v_mov_b32 v6, s44
    v_mov_b32 v7, s70
    v_and_b32 v8, 31, v2
    v_lshlrev_b32 v8, 2, v8
    s_waitcnt vmcnt(0)
    buffer_store_dword v6, v7, s[40:43], s68 offen sc1
L_h3_q:
    s_sleep 16
    buffer_load_dword v6, v10, s[40:43], s74 offen sc1
    buffer_load_dword v7, v8, s[40:43], s68 offen sc1
    s_add_u32 s69, s69, 1
    s_waitcnt vmcnt(0)
    v_cmp_ne_u32 vcc, s45, v6
    v_cmp_ne_u32 s[70:71], s44, v7
    s_nop 1
    s_and_b64 vcc, vcc, s[70:71]
    s_cbranch_vccz L_h3_r
    s_cmp_lt_u32 s69, 400000
    s_cbranch_scc1 L_h3_q
L_h3_r:
    buffer_inv sc1
    s_waitcnt vmcnt(0)
L_h3_ok:
    s_mov_b32 s68, s73
    s_mov_b32 m0, 72192
    s_nop 0
    buffer_load_dwordx4 v12, s[96:99], s68 offen sc1 lds
    s_add_u32 s68, s68, 9216
    s_mov_b32 m0, 73216
    s_nop 0
    buffer_load_dwordx4 v12, s[96:99], s68 offen sc1 lds
    s_add_u32 s68, s68, 9216
    s_mov_b32 m0, 74240
    s_nop 0
    buffer_load_dwordx4 v12, s[96:99], s68 offen sc1 lds
    s_add_u32 s68, s68, 9216
    s_mov_b32 m0, 75264
    s_nop 0
    buffer_load_dwordx4 v12, s[96:99], s68 offen sc1 lds
    s_add_u32 s68, s68, 9216
    s_mov_b32 m0, 76288
    s_nop 0
    buffer_load_dwordx4 v12, s[96:99], s68 offen sc1 lds
    s_add_u32 s68, s68, 9216
    s_mov_b32 m0, 77312
    s_nop 0
    buffer_load_dwordx4 v12, s[96:99], s68 offen sc1 lds
    s_add_u32 s68, s68, 9216
    s_mov_b32 m0, 78336
    s_nop 0
    buffer_load_dwordx4 v12, s[96:99], s68 offen sc1 lds
    s_add_u32 s68, s68, 9216
    s_mov_b32 m0, 79360
    s_nop 0
    buffer_load_dwordx4 v12, s[96:99], s68 offen sc1 lds
    s_waitcnt vmcnt(0)
    v_mov_b32 v6, 1
    ds_write_b32 v5, v6 offset:52
L_t2:
    s_and_b32 s69, s3, 3
    s_mul_i32 s68, s69, 18432
    s_add_u32 s73, s73, s68
    s_add_u32 s72, s73, 9216
    s_lshl_b32 s68, s69, 2
    v_lshrrev_b32 v15, 2, v14
    v_add_u32 v15, s68, v15
    v_xor_b32 v15, v15, v13
    v_lshlrev_b32 v15, 4, v15
    v_and_b32 v14, 3, v14
    v_lshl_add_u32 v15, v14, 2, v15
    v_lshl_add_u32 v15, v13, 10, v15
    v_xor_b32 v16, 32, v15
    v_add_u32 v15, 72192, v15
    v_add_u32 v16, 72192, v16
L_tw:
    ds_read_b32 v6, v5 offset:52
    s_waitcnt lgkmcnt(0)
    v_readfirstlane_b32 s68, v6
    s_cmp_lg_u32 s68, 1
    s_cbranch_scc1 L_tw
    ds_read2st64_b32 v[32:33], v15 offset0:0 offset1:1
    ds_read2st64_b32 v[34:35], v15 offset0:2 offset1:3
    ds_read2st64_b32 v[36:37], v16 offset0:0 offset1:1
    ds_read2st64_b32 v[38:39], v16 offset0:2 offset1:3
    s_waitcnt lgkmcnt(2)
    buffer_store_dwordx4 v[32:35], v12, s[96:99], s73 offen
    s_waitcnt lgkmcnt(0)
    buffer_store_dwordx4 v[36:39], v12, s[96:99], s72 offen
    s_endpgm
L_aux:
    s_setprio 2
    s_and_b32 s68, s3, 1
    s_bfe_u32 s69, s3, 0x10001
    s_lshl_b32 s70, s3, 11
    s_add_u32 s70, s70, 141824
    v_lshrrev_b32 v6, 1, v3
    v_and_b32 v6, 3, v6
    v_xor_b32 v6, v6, v4
    v_lshl_add_u32 v6, v3, 2, v6
    v_lshl_add_u32 v13, v6, 4, s70
    v_lshrrev_b32 v6, 3, v2
    v_and_b32 v6, 3, v6
    v_xor_b32 v6, v6, v2
    v_lshl_add_u32 v14, v6, 4, s70
    s_lshl_b32 s70, s39, 6
    s_lshl_b32 s71, s68, 5
    s_add_u32 s70, s70, s71
    s_mul_i32 s70, s70, 1152
    s_lshl_b32 s71, s38, 7
    s_add_u32 s70, s70, s71
    s_lshl_b32 s71, s69, 6
    s_add_u32 s70, s70, s71
    v_lshrrev_b32 v6, 2, v2
    v_mul_u32_u24 v6, 2304, v6
    v_and_b32 v7, 3, v2
    v_lshl_add_u32 v6, v7, 4, v6
    v_add_u32 v15, s70, v6
    s_lshl_b32 s70, s38, 18
    s_lshl_b32 s71, s68, 17
    s_add_u32 s70, s70, s71
    s_lshl_b32 s71, s39, 7
    s_add_u32 s70, s70, s71
    s_lshl_b32 s71, s69, 6
    s_add_u32 s70, s70, s71
    s_add_u32 s70, s70, 2097152
    v_lshrrev_b32 v6, 2, v2
    v_lshlrev_b32 v6, 13, v6
    v_lshl_add_u32 v6, v7, 4, v6
    v_add_u32 v17, s70, v6
    s_lshl_b32 s70, s39, 13
    s_lshl_b32 s71, s69, 12
    s_add_u32 s70, s70, s71
    s_lshl_b32 s71, s38, 7
    s_add_u32 s70, s70, s71
    s_lshl_b32 s71, s68, 6
    s_add_u32 s70, s70, s71
    s_add_u32 s70, s70, 1048576
    v_lshlrev_b32 v16, 10, v4
    v_lshl_add_u32 v16, v3, 2, v16
    v_add_u32 v16, s70, v16
    s_lshl_b32 s72, s68, 8
    s_lshl_b32 s71, s39, 3
    s_add_u32 s72, s72, s71
    s_lshl_b32 s71, s69, 2
    s_add_u32 s72, s72, s71
    s_waitcnt vmcnt(32)
    v_lshlrev_b32 v96, 16, v92
    v_lshlrev_b32 v97, 16, v94
    v_and_b32 v98, s51, v92
    v_and_b32 v99, s51, v94
    v_lshlrev_b32 v100, 16, v93
    v_lshlrev_b32 v101, 16, v95
    v_and_b32 v102, s51, v93
    v_and_b32 v103, s51, v95
    s_waitcnt vmcnt(21)
    v_cmp_gt_u32 vcc, 5184, v10
    s_nop 1
    v_cndmask_b32 v64, v64, 0, vcc
    v_cndmask_b32 v65, v65, 0, vcc
    v_cndmask_b32 v66, v66, 0, vcc
    v_lshlrev_b32 v104, 16, v64
    v_and_b32 v105, s51, v64
    v_lshlrev_b32 v106, 16, v65
    v_and_b32 v107, s51, v65
    v_lshlrev_b32 v108, 16, v66
    v_and_b32 v109, s51, v66
    v_lshlrev_b32 v110, 16, v67
    v_and_b32 v111, s51, v67
    v_lshlrev_b32 v112, 16, v68
    v_and_b32 v113, s51, v68
    v_lshlrev_b32 v114, 16, v69
    v_and_b32 v115, s51, v69
    v_lshlrev_b32 v116, 16, v70
    v_and_b32 v117, s51, v70
    v_lshlrev_b32 v118, 16, v71
    v_and_b32 v119, s51, v71
    v_lshlrev_b32 v120, 16, v72
    v_and_b32 v121, s51, v72
    v_lshlrev_b32 v122, 16, v73
    v_and_b32 v123, s51, v73
    v_lshlrev_b32 v124, 16, v74
    v_and_b32 v125, s51, v74
    .p2align 3
    v_pk_mul_f32 v[126:127], v[110:111], v[96:97]
    v_pk_mul_f32 v[128:129], v[112:113], v[96:97]
    v_pk_mul_f32 v[130:131], v[114:115], v[96:97]
    v_pk_mul_f32 v[132:133], v[116:117], v[96:97]
    v_pk_mul_f32 v[134:135], v[118:119], v[96:97]
    v_pk_mul_f32 v[136:137], v[120:121], v[96:97]
    v_pk_mul_f32 v[138:139], v[122:123], v[96:97]
    v_pk_mul_f32 v[140:141], v[124:125], v[96:97]
    v_pk_fma_f32 v[126:127], v[108:109], v[98:99], v[126:127]
    v_pk_fma_f32 v[128:129], v[110:111], v[98:99], v[128:129]
    v_pk_fma_f32 v[130:131], v[112:113], v[98:99], v[130:131]
    v_pk_fma_f32 v[132:133], v[114:115], v[98:99], v[132:133]
    v_pk_fma_f32 v[134:135], v[116:117], v[98:99], v[134:135]
    v_pk_fma_f32 v[136:137], v[118:119], v[98:99], v[136:137]
    v_pk_fma_f32 v[138:139], v[120:121], v[98:99], v[138:139]
    v_pk_fma_f32 v[140:141], v[122:123], v[98:99], v[140:141]
    v_pk_fma_f32 v[126:127], v[106:107], v[100:101], v[126:127]
    v_pk_fma_f32 v[128:129], v[108:109], v[100:101], v[128:129]
    v_pk_fma_f32 v[130:131], v[110:111], v[100:101], v[130:131]
    v_pk_fma_f32 v[132:133], v[112:113], v[100:101], v[132:133]
    v_pk_fma_f32 v[134:135], v[114:115], v[100:101], v[134:135]
    v_pk_fma_f32 v[136:137], v[116:117], v[100:101], v[136:137]
    v_pk_fma_f32 v[138:139], v[118:119], v[100:101], v[138:139]
    v_pk_fma_f32 v[140:141], v[120:121], v[100:101], v[140:141]
    v_pk_fma_f32 v[126:127], v[104:105], v[102:103], v[126:127]
    v_pk_fma_f32 v[128:129], v[106:107], v[102:103], v[128:129]
    v_pk_fma_f32 v[130:131], v[108:109], v[102:103], v[130:131]
    v_pk_fma_f32 v[132:133], v[110:111], v[102:103], v[132:133]
    v_pk_fma_f32 v[134:135], v[112:113], v[102:103], v[134:135]
    v_pk_fma_f32 v[136:137], v[114:115], v[102:103], v[136:137]
    v_pk_fma_f32 v[138:139], v[116:117], v[102:103], v[138:139]
    v_pk_fma_f32 v[140:141], v[118:119], v[102:103], v[140:141]
    s_waitcnt vmcnt(13)
    v_lshlrev_b32 v104, 16, v76
    v_and_b32 v105, s51, v76
    v_lshlrev_b32 v106, 16, v77
    v_and_b32 v107, s51, v77
    v_lshlrev_b32 v108, 16, v78
    v_and_b32 v109, s51, v78
    v_lshlrev_b32 v110, 16, v79
    v_and_b32 v111, s51, v79
    v_lshlrev_b32 v112, 16, v80
    v_and_b32 v113, s51, v80
    v_lshlrev_b32 v114, 16, v81
    v_and_b32 v115, s51, v81
    v_lshlrev_b32 v116, 16, v82
    v_and_b32 v117, s51, v82
    v_lshlrev_b32 v118, 16, v83
    v_and_b32 v119, s51, v83
    .p2align 3
    v_pk_mul_f32 v[126:127], v[126:127], v[104:105]
    v_pk_mul_f32 v[128:129], v[128:129], v[106:107]
    v_pk_mul_f32 v[130:131], v[130:131], v[108:109]
    v_pk_mul_f32 v[132:133], v[132:133], v[110:111]
    v_pk_mul_f32 v[134:135], v[134:135], v[112:113]
    v_pk_mul_f32 v[136:137], v[136:137], v[114:115]
    v_pk_mul_f32 v[138:139], v[138:139], v[116:117]
    v_pk_mul_f32 v[140:141], v[140:141], v[118:119]
    v_cvt_pk_bf16_f32 v144, v140, v138
    v_cvt_pk_bf16_f32 v145, v136, v134
    v_cvt_pk_bf16_f32 v146, v132, v130
    v_cvt_pk_bf16_f32 v147, v128, v126
    v_cvt_pk_bf16_f32 v148, v141, v139
    v_cvt_pk_bf16_f32 v149, v137, v135
    v_cvt_pk_bf16_f32 v150, v133, v131
    v_cvt_pk_bf16_f32 v151, v129, v127
    ds_write_b128 v13, v[144:147]
    ds_write_b128 v13, v[148:151] offset:1024
    ds_read_b128 v[152:155], v14
    ds_read_b128 v[156:159], v14 offset:1024
    s_waitcnt lgkmcnt(0)
    s_add_u32 s44, s44, 0x9e3779b0
    s_and_b32 s44, s44, -16
    s_or_b32 s45, s45, s44
    s_bitcmp1_b32 s75, 0
    s_cselect_b32 s75, 0, 16
    s_lshl_b32 s16, s16, s75
    s_and_b32 s16, s16, s51
    buffer_store_dwordx4 v[152:155], v15, s[96:99], 0 offen
    buffer_store_dwordx4 v[156:159], v15, s[96:99], 0 offen offset:1152
    v_mov_b32 v26, 0
    v_mov_b32 v27, s44
    s_waitcnt vmcnt(6)
    s_mov_b32 s68, 0x05040100
    s_mov_b32 s69, 0x07060302
    v_perm_b32 v144, v90, v91, s68
    v_perm_b32 v145, v88, v89, s68
    v_perm_b32 v146, v86, v87, s68
    v_perm_b32 v147, v84, v85, s68
    v_perm_b32 v148, v90, v91, s69
    v_perm_b32 v149, v88, v89, s69
    v_perm_b32 v150, v86, v87, s69
    v_perm_b32 v151, v84, v85, s69
    ds_write_b128 v13, v[144:147]
    ds_write_b128 v13, v[148:151] offset:1024
    ds_read_b128 v[152:155], v14
    ds_read_b128 v[156:159], v14 offset:1024
    v_dot2_f32_bf16 v104, v84, v75, 0
    v_dot2_f32_bf16 v105, v85, v75, 0
    v_dot2_f32_bf16 v106, v86, v75, 0
    v_dot2_f32_bf16 v107, v87, v75, 0
    v_dot2_f32_bf16 v108, v88, v75, 0
    v_dot2_f32_bf16 v109, v89, v75, 0
    v_dot2_f32_bf16 v110, v90, v75, 0
    v_dot2_f32_bf16 v111, v91, v75, 0
    v_add_f32 v112, v104, v104 row_ror:8 row_mask:0xf bank_mask:0x3
    v_add_f32 v113, v105, v105 row_ror:8 row_mask:0xf bank_mask:0x3
    v_add_f32 v114, v106, v106 row_ror:8 row_mask:0xf bank_mask:0x3
    v_add_f32 v115, v107, v107 row_ror:8 row_mask:0xf bank_mask:0x3
    v_add_f32 v112, v108, v108 row_ror:8 row_mask:0xf bank_mask:0xc
    v_add_f32 v113, v109, v109 row_ror:8 row_mask:0xf bank_mask:0xc
    v_add_f32 v114, v110, v110 row_ror:8 row_mask:0xf bank_mask:0xc
    v_add_f32 v115, v111, v111 row_ror:8 row_mask:0xf bank_mask:0xc
    v_add_f32 v104, v112, v112 row_shl:4 row_mask:0xf bank_mask:0x5
    v_add_f32 v105, v113, v113 row_shl:4 row_mask:0xf bank_mask:0x5
    s_nop 0
    v_add_f32 v104, v114, v114 row_shr:4 row_mask:0xf bank_mask:0xa
    v_add_f32 v105, v115, v115 row_shr:4 row_mask:0xf bank_mask:0xa
    s_nop 0
    v_add_f32 v106, v104, v104 quad_perm:[1,0,3,2] row_mask:0xf bank_mask:0xf
    v_add_f32 v107, v105, v105 quad_perm:[1,0,3,2] row_mask:0xf bank_mask:0xf
    s_nop 0
    v_add_f32 v24, v106, v106 quad_perm:[2,3,0,1] row_mask:0xf bank_mask:0xf
    v_add_f32 v25, v107, v107 quad_perm:[2,3,0,1] row_mask:0xf bank_mask:0xf
    s_movk_i32 s68, 4096
    s_waitcnt lgkmcnt(0)
    buffer_store_dwordx4 v[152:155], v17, s[40:43], 0 offen
    buffer_store_dwordx4 v[156:159], v17, s[40:43], s68 offen
    s_mov_b32 exec_lo, 0x11111111
    s_mov_b32 exec_hi, 0x11111111
    buffer_store_dwordx4 v[24:27], v16, s[40:43], 0 offen sc1
    s_mov_b64 exec, -1
    v_mov_b32 v6, s45
    v_mov_b32 v7, s72
    v_mov_b32 v8, 1
    s_mov_b64 exec, 1
    s_waitcnt vmcnt(1)
    buffer_store_dword v6, v7, s[40:43], s74 offen offset:0
    s_mov_b64 exec, -1
    s_cmp_eq_u32 s3, 4
    s_cbranch_scc1 L_nohs
    s_setprio 0
    v_lshl_add_u32 v9, v2, 4, s47
    v_mov_b32 v176, 0
    s_mov_b64 exec, 1
    v_lshlrev_b32 v6, 16, v160
    v_add_f32 v6, s16, v6
    v_cvt_pk_bf16_f32 v6, v6, v6
    v_bfi_b32 v160, s51, v160, v6
    s_mov_b64 exec, -1
    v_mov_b32 v177, v163 wave_ror:1 row_mask:0xf bank_mask:0xf
    v_mov_b32 v178, v167 wave_ror:1 row_mask:0xf bank_mask:0xf
    v_mov_b32 v179, v171 wave_ror:1 row_mask:0xf bank_mask:0xf
    v_mov_b32 v176, v163 wave_shr:1 row_mask:0xf bank_mask:0xf
    v_mov_b32 v177, v167 wave_shr:1 row_mask:0xf bank_mask:0xf
    v_mov_b32 v178, v171 wave_shr:1 row_mask:0xf bank_mask:0xf
    v_mov_b32 v179, v175 wave_shr:1 row_mask:0xf bank_mask:0xf
    v_alignbit_b32 v180, v160, v176, 16
    v_alignbit_b32 v181, v161, v160, 16
    v_alignbit_b32 v182, v162, v161, 16
    v_alignbit_b32 v183, v163, v162, 16
    v_alignbit_b32 v184, v164, v177, 16
    v_alignbit_b32 v185, v165, v164, 16
    v_alignbit_b32 v186, v166, v165, 16
    v_alignbit_b32 v187, v167, v166, 16
    v_alignbit_b32 v188, v168, v178, 16
    v_alignbit_b32 v189, v169, v168, 16
    v_alignbit_b32 v190, v170, v169, 16
    v_alignbit_b32 v191, v171, v170, 16
    v_alignbit_b32 v192, v172, v179, 16
    v_alignbit_b32 v193, v173, v172, 16
    v_alignbit_b32 v194, v174, v173, 16
    v_alignbit_b32 v195, v175, v174, 16
    ds_write_b128 v9, v[160:163] offset:32
    ds_write_b128 v9, v[180:183] offset:4192
    ds_write_b128 v9, v[164:167] offset:1056
    ds_write_b128 v9, v[184:187] offset:5216
    ds_write_b128 v9, v[168:171] offset:2080
    ds_write_b128 v9, v[188:191] offset:6240
    ds_write_b128 v9, v[172:175] offset:3104
    ds_write_b128 v9, v[192:195] offset:7264
    s_setprio 2
L_nohs:
    v_lshlrev_b32 v51, 4, v2
    s_lshl_b32 s52, s2, 10
    s_add_u32 s52, s52, 1048576
    s_lshl_b32 s55, s38, 18
    s_lshl_b32 s68, s39, 13
    s_add_u32 s55, s55, s68
    s_add_u32 s55, s55, 2097152
    s_waitcnt lgkmcnt(0)
    s_barrier
    s_cmp_eq_u32 s3, 5
    s_cbranch_scc1 L_recv
    s_cmp_eq_u32 s3, 4
    s_cbranch_scc1 L_gp
    s_cmp_eq_u32 s3, 7
    s_cbranch_scc1 L_set
    v_mul_u32_u24 v7, 1152, v2
    s_mul_i32 s68, s2, 9216
    s_mov_b64 exec, 0xff
    buffer_load_dword v152, v7, s[96:99], s68 offen offset:1024 sc1
    s_mov_b64 exec, -1
    s_branch L_set
L_recv:
    s_add_u32 s71, s55, 4096
    s_mov_b32 m0, 131840
    s_nop 0
    buffer_load_dwordx4 v51, s[40:43], s55 offen offset:0 sc1 lds
    buffer_load_dwordx4 v51, s[40:43], s55 offen offset:1024 sc1 lds
    buffer_load_dwordx4 v51, s[40:43], s55 offen offset:2048 sc1 lds
    buffer_load_dwordx4 v51, s[40:43], s55 offen offset:3072 sc1 lds
    s_mov_b32 m0, 136448
    s_nop 0
    buffer_load_dwordx4 v51, s[40:43], s71 offen offset:0 sc1 lds
    buffer_load_dwordx4 v51, s[40:43], s71 offen offset:1024 sc1 lds
    buffer_load_dwordx4 v51, s[40:43], s71 offen offset:2048 sc1 lds
    buffer_load_dwordx4 v51, s[40:43], s71 offen offset:3072 sc1 lds
    s_branch L_set
L_gp:
    v_and_b32 v11, 3, v2
    v_lshl_add_u32 v12, v11, 3, v5
    ds_read_b64 v[80:81], v12 offset:128
    ds_read_b64 v[82:83], v12 offset:160
    buffer_load_dwordx4 v[128:131], v51, s[40:43], s52 offen offset:0 sc1
L_set:
    s_setprio 0
    s_lshr_b32 s68, s39, 2
    v_xor_b32 v6, s68, v2
    s_and_b32 s73, s3, 3
    s_lshl_b32 s69, s73, 11
    s_add_u32 s53, s69, 1310720
    v_lshrrev_b32 v8, 3, v6
    v_and_b32 v8, 3, v8
    v_xor_b32 v8, v8, v6
    v_lshl_add_u32 v44, v8, 4, s69
    s_lshl_b32 s69, s73, 10
    v_lshl_add_u32 v50, v2, 3, s69
    s_add_u32 s70, s69, 8192
    v_lshl_add_u32 v52, v8, 4, s70
    v_xor_b32 v6, 1, v6
    s_add_u32 s70, s69, 122624
    v_lshl_add_u32 v45, v6, 3, s70
    v_lshlrev_b32 v46, 4, v6
    v_lshrrev_b32 v7, 2, v2
    v_and_b32 v8, 3, v2
    v_lshlrev_b32 v6, 7, v7
    v_lshl_add_u32 v48, v8, 4, v6
    v_lshrrev_b32 v6, 1, v8
    v_mul_u32_u24 v6, 4608, v6
    s_add_u32 s70, s69, 145664
    v_sub_u32 v6, s70, v6
    v_lshl_add_u32 v6, v7, 4, v6
    v_and_b32 v8, 1, v8
    v_lshl_add_u32 v49, v8, 3, v6
    s_lshl_b32 s69, s73, 9
    s_lshl_b32 s70, s39, 1
    s_add_u32 s69, s69, s70
    s_mul_i32 s69, s69, 1152
    s_lshl_b32 s70, s38, 7
    s_add_u32 s69, s69, s70
    v_lshlrev_b32 v6, 6, v4
    v_bfe_u32 v7, v2, 3, 1
    v_add_u32 v6, v6, v7
    v_mul_u32_u24 v6, 1152, v6
    v_and_b32 v7, 7, v2
    v_lshl_add_u32 v6, v7, 4, v6
    v_add_u32 v47, s69, v6
    s_sub_u32 s68, s46, 512
    s_lshr_b32 s69, s68, 1
    s_lshl_b32 s69, s69, 15
    s_and_b32 s68, s68, 1
    s_lshl_b32 s68, s68, 6
    s_add_u32 s54, s68, s69
    s_lshl_b32 s68, s73, 13
    s_add_u32 s54, s54, s68
    s_lshl_b32 s56, s73, 7
    s_lshl_b32 s68, s39, 2
    s_add_u32 s56, s56, s68
    s_cmp_lg_u32 s3, 4
    s_cbranch_scc1 L_ngp
    s_mov_b32 s69, 0
    s_branch L_rp_c
L_rp:
    buffer_load_dwordx4 v[128:131], v51, s[40:43], s52 offen offset:0 sc1
L_rp_c:
    s_add_u32 s69, s69, 1
    s_waitcnt vmcnt(0)
    v_xor_b32 v131, s44, v131
    v_cmp_ne_u32 vcc, 0, v131
    s_cbranch_vccz L_rp_ok
    s_sleep 4
    s_cmp_lt_u32 s69, 25000
    s_cbranch_scc1 L_rp
L_rp_ok:
    s_waitcnt lgkmcnt(0)
    v_add_f32 v132, v128, v128 row_ror:4 row_mask:0xf bank_mask:0xf
    v_add_f32 v133, v129, v129 row_ror:4 row_mask:0xf bank_mask:0xf
    s_nop 0
    v_add_f32 v128, v132, v132 row_ror:8 row_mask:0xf bank_mask:0xf
    v_add_f32 v129, v133, v133 row_ror:8 row_mask:0xf bank_mask:0xf
    v_mov_b32 v132, v128
    v_mov_b32 v133, v129
    s_nop 0
    v_permlane16_swap_b32 v128, v132
    v_permlane16_swap_b32 v129, v133
    v_add_f32 v128, v128, v132
    v_add_f32 v129, v129, v133
    v_mov_b32 v132, v128
    v_mov_b32 v133, v129
    s_nop 0
    v_permlane32_swap_b32 v128, v132
    v_permlane32_swap_b32 v129, v133
    v_add_f32 v80, v80, v82
    v_add_f32 v81, v81, v83
    v_add_f32 v128, v128, v132
    v_add_f32 v129, v129, v133
    v_add_f32 v128, v128, v80
    v_add_f32 v129, v129, v81
    v_mul_f32 v128, 0xbfb8aa3b, v128
    v_mul_f32 v129, 0xbfb8aa3b, v129
    v_exp_f32 v128, v128
    v_exp_f32 v129, v129
    v_add_f32 v128, 1.0, v128
    v_add_f32 v129, 1.0, v129
    v_rcp_f32 v128, v128
    v_rcp_f32 v129, v129
    v_mov_b32 v26, 0
    v_mov_b32 v27, s44
    v_cvt_pk_bf16_f32 v128, v129, v128
    s_lshl_b32 s70, s2, 5
    s_add_u32 s70, s70, 1310720
    v_mov_b32 v24, v128 quad_perm:[3,1,3,1] row_mask:0xf bank_mask:0xf
    v_mov_b32 v25, v128 quad_perm:[2,0,2,0] row_mask:0xf bank_mask:0xf

    s_setprio 2
    s_mov_b64 exec, 3
    buffer_store_dwordx4 v[24:27], v51, s[40:43], s70 offen sc1
    s_mov_b64 exec, -1
L_ngp:
    s_setprio 2
    s_cmp_lg_u32 s3, 5
    s_cbranch_scc1 L_xw
    s_waitcnt vmcnt(0)
    v_mov_b32 v6, 1
    ds_write_b32 v5, v6 offset:0
    s_branch L_xok
L_xw:
    s_sleep 2
    ds_read_b32 v6, v5 offset:0
    s_waitcnt lgkmcnt(0)
    v_readfirstlane_b32 s68, v6
    s_cmp_lg_u32 s68, 1
    s_cbranch_scc1 L_xw
L_xok:
    s_add_u32 s70, s54, 4096
    buffer_load_dwordx4 v[128:131], v48, s[40:43], s54 offen offset:0 sc1
    buffer_load_dwordx4 v[132:135], v48, s[40:43], s54 offen offset:2048 sc1
    buffer_load_dwordx4 v[136:139], v48, s[40:43], s70 offen offset:0 sc1
    buffer_load_dwordx4 v[140:143], v48, s[40:43], s70 offen offset:2048 sc1
    ds_read_b64 v[168:169], v45 offset:9216
    ds_read_b64 v[170:171], v45 offset:13824
    ds_read_b64 v[172:173], v45 offset:9728
    ds_read_b64 v[174:175], v45 offset:14336
    s_setprio 0
    s_waitcnt lgkmcnt(0)
    v_and_b32 v64, s51, v169
    v_lshlrev_b32 v65, 16, v169
    v_and_b32 v66, s51, v168
    v_lshlrev_b32 v67, 16, v168
    v_and_b32 v68, s51, v171
    v_lshlrev_b32 v69, 16, v171
    v_and_b32 v70, s51, v170
    v_lshlrev_b32 v71, 16, v170
    v_and_b32 v72, s51, v173
    v_lshlrev_b32 v73, 16, v173
    v_and_b32 v74, s51, v172
    v_lshlrev_b32 v75, 16, v172
    v_and_b32 v76, s51, v175
    v_lshlrev_b32 v77, 16, v175
    v_and_b32 v78, s51, v174
    v_lshlrev_b32 v79, 16, v174
    s_mov_b32 s69, 0
    s_branch L_rx_c
L_rx:
    s_add_u32 s70, s54, 4096
    buffer_load_dwordx4 v[128:131], v48, s[40:43], s54 offen offset:0 sc1
    buffer_load_dwordx4 v[132:135], v48, s[40:43], s54 offen offset:2048 sc1
    buffer_load_dwordx4 v[136:139], v48, s[40:43], s70 offen offset:0 sc1
    buffer_load_dwordx4 v[140:143], v48, s[40:43], s70 offen offset:2048 sc1
L_rx_c:
    s_add_u32 s69, s69, 1
    s_waitcnt vmcnt(0)
    v_xor_b32 v131, s44, v131
    v_xor_b32 v135, s44, v135
    v_xor_b32 v139, s44, v139
    v_xor_b32 v143, s44, v143
    v_or_b32 v131, v131, v135
    v_or_b32 v131, v131, v139
    v_or_b32 v131, v131, v143
    v_cmp_ne_u32 vcc, 0, v131
    s_cbranch_vccz L_rx_ok
    s_sleep 4
    s_cmp_lt_u32 s69, 25000
    s_cbranch_scc1 L_rx
L_rx_ok:
    s_setprio 2
    ds_write_b64 v49, v[128:129] offset:0
    ds_write_b64 v49, v[132:133] offset:256
    ds_write_b64 v49, v[136:137] offset:512
    ds_write_b64 v49, v[140:141] offset:768
    v_mov_b32 v6, 1
    s_mov_b64 exec, 1
    ds_add_u32 v5, v6 offset:24
    s_mov_b64 exec, -1
L_aw:
    ds_read_b128 v[24:27], v5 offset:32
    s_waitcnt lgkmcnt(0)
    v_and_b32 v24, v24, v25
    v_and_b32 v26, v26, v27
    v_and_b32 v24, v24, v26
    s_nop 0
    v_readfirstlane_b32 s68, v24
    s_cmp_eq_u32 s68, 1
    s_cbranch_scc1 L_aw_ok
    s_sleep 2
    s_branch L_aw
L_aw_ok:
    buffer_load_dwordx4 v[128:131], v46, s[40:43], s53 offen offset:0 sc1
    buffer_load_dwordx4 v[132:135], v46, s[40:43], s53 offen offset:1024 sc1
    ds_read_b128 v[160:163], v52 offset:0
    ds_read_b128 v[164:167], v52 offset:18048
    ds_read_b128 v[168:171], v52 offset:36096
    ds_read_b128 v[172:175], v52 offset:54144
    s_setprio 0
    s_waitcnt lgkmcnt(0)
    v_lshlrev_b32 v80, 16, v160
    v_and_b32 v81, s51, v160
    v_lshlrev_b32 v82, 16, v161
    v_and_b32 v83, s51, v161
    v_lshlrev_b32 v84, 16, v164
    v_and_b32 v85, s51, v164
    v_lshlrev_b32 v86, 16, v165
    v_and_b32 v87, s51, v165
    v_lshlrev_b32 v88, 16, v168
    v_and_b32 v89, s51, v168
    v_lshlrev_b32 v90, 16, v169
    v_and_b32 v91, s51, v169
    v_lshlrev_b32 v92, 16, v172
    v_and_b32 v93, s51, v172
    v_lshlrev_b32 v94, 16, v173
    v_and_b32 v95, s51, v173
    v_add_f32 v80, v80, v88
    v_add_f32 v81, v81, v89
    v_add_f32 v82, v82, v90
    v_add_f32 v83, v83, v91
    v_add_f32 v84, v84, v92
    v_add_f32 v85, v85, v93
    v_add_f32 v86, v86, v94
    v_add_f32 v87, v87, v95
    v_mul_f32 v64, v64, v80
    v_mul_f32 v65, v65, v81
    v_mul_f32 v66, v66, v82
    v_mul_f32 v67, v67, v83
    v_mul_f32 v68, v68, v84
    v_mul_f32 v69, v69, v85
    v_mul_f32 v70, v70, v86
    v_mul_f32 v71, v71, v87
    v_lshlrev_b32 v80, 16, v162
    v_and_b32 v81, s51, v162
    v_lshlrev_b32 v82, 16, v163
    v_and_b32 v83, s51, v163
    v_lshlrev_b32 v84, 16, v166
    v_and_b32 v85, s51, v166
    v_lshlrev_b32 v86, 16, v167
    v_and_b32 v87, s51, v167
    v_lshlrev_b32 v88, 16, v170
    v_and_b32 v89, s51, v170
    v_lshlrev_b32 v90, 16, v171
    v_and_b32 v91, s51, v171
    v_lshlrev_b32 v92, 16, v174
    v_and_b32 v93, s51, v174
    v_lshlrev_b32 v94, 16, v175
    v_and_b32 v95, s51, v175
    v_add_f32 v80, v80, v88
    v_add_f32 v81, v81, v89
    v_add_f32 v82, v82, v90
    v_add_f32 v83, v83, v91
    v_add_f32 v84, v84, v92
    v_add_f32 v85, v85, v93
    v_add_f32 v86, v86, v94
    v_add_f32 v87, v87, v95
    v_mul_f32 v72, v72, v80
    v_mul_f32 v73, v73, v81
    v_mul_f32 v74, v74, v82
    v_mul_f32 v75, v75, v83
    v_mul_f32 v76, v76, v84
    v_mul_f32 v77, v77, v85
    v_mul_f32 v78, v78, v86
    v_mul_f32 v79, v79, v87
    s_mov_b32 s69, 0
    s_branch L_rg_c
L_rg:
    buffer_load_dwordx4 v[128:131], v46, s[40:43], s53 offen offset:0 sc1
    buffer_load_dwordx4 v[132:135], v46, s[40:43], s53 offen offset:1024 sc1
L_rg_c:
    s_add_u32 s69, s69, 1
    s_waitcnt vmcnt(0)
    v_xor_b32 v131, s44, v131
    v_xor_b32 v135, s44, v135
    v_or_b32 v131, v131, v135
    v_cmp_ne_u32 vcc, 0, v131
    s_cbranch_vccz L_rg_ok
    s_sleep 4
    s_cmp_lt_u32 s69, 25000
    s_cbranch_scc1 L_rg
L_rg_ok:
    v_and_b32 v112, s51, v129
    v_lshlrev_b32 v113, 16, v129
    v_and_b32 v114, s51, v128
    v_lshlrev_b32 v115, 16, v128
    v_mul_f32 v64, v64, v112
    v_mul_f32 v65, v65, v113
    v_mul_f32 v66, v66, v114
    v_mul_f32 v67, v67, v115
    v_mul_f32 v68, v68, v112
    v_mul_f32 v69, v69, v113
    v_mul_f32 v70, v70, v114
    v_mul_f32 v71, v71, v115
    v_and_b32 v116, s51, v133
    v_lshlrev_b32 v117, 16, v133
    v_and_b32 v118, s51, v132
    v_lshlrev_b32 v119, 16, v132
    v_mul_f32 v72, v72, v116
    v_mul_f32 v73, v73, v117
    v_mul_f32 v74, v74, v118
    v_mul_f32 v75, v75, v119
    v_mul_f32 v76, v76, v116
    v_mul_f32 v77, v77, v117
    v_mul_f32 v78, v78, v118
    v_mul_f32 v79, v79, v119
    s_setprio 2
L_edw:
    ds_read_b128 v[24:27], v5 offset:96
    s_waitcnt lgkmcnt(0)
    v_and_b32 v24, v24, v25
    v_and_b32 v26, v26, v27
    v_and_b32 v24, v24, v26
    s_nop 0
    v_readfirstlane_b32 s68, v24
    s_cmp_eq_u32 s68, 1
    s_cbranch_scc1 L_edw_ok
    s_sleep 1
    s_branch L_edw
L_edw_ok:
    ds_read_b128 v[160:163], v52 offset:4096
    ds_read_b128 v[164:167], v52 offset:22144
    ds_read_b128 v[168:171], v52 offset:40192
    ds_read_b128 v[172:175], v52 offset:58240
    ds_read_b64 v[176:177], v45 offset:23040
    ds_read_b64 v[178:179], v45 offset:23552
    s_setprio 0
    s_waitcnt lgkmcnt(0)
    v_lshlrev_b32 v128, 16, v160
    v_and_b32 v129, s51, v160
    v_lshlrev_b32 v130, 16, v161
    v_and_b32 v131, s51, v161
    v_lshlrev_b32 v132, 16, v164
    v_and_b32 v133, s51, v164
    v_lshlrev_b32 v134, 16, v165
    v_and_b32 v135, s51, v165
    v_lshlrev_b32 v136, 16, v168
    v_and_b32 v137, s51, v168
    v_lshlrev_b32 v138, 16, v169
    v_and_b32 v139, s51, v169
    v_lshlrev_b32 v140, 16, v172
    v_and_b32 v141, s51, v172
    v_lshlrev_b32 v142, 16, v173
    v_and_b32 v143, s51, v173
    v_and_b32 v148, s51, v177
    v_lshlrev_b32 v149, 16, v177
    v_and_b32 v150, s51, v176
    v_lshlrev_b32 v151, 16, v176
    v_add_f32 v128, v128, v136
    v_add_f32 v129, v129, v137
    v_add_f32 v130, v130, v138
    v_add_f32 v131, v131, v139
    v_add_f32 v132, v132, v140
    v_add_f32 v133, v133, v141
    v_add_f32 v134, v134, v142
    v_add_f32 v135, v135, v143
    v_fma_f32 v128, v128, v148, -v132
    v_fma_f32 v129, v129, v149, -v133
    v_fma_f32 v130, v130, v150, -v134
    v_fma_f32 v131, v131, v151, -v135
    v_fmac_f32 v132, v128, v112
    v_fmac_f32 v133, v129, v113
    v_fmac_f32 v134, v130, v114
    v_fmac_f32 v135, v131, v115
    v_cvt_pk_bf16_f32 v40, v132, v133
    v_cvt_pk_bf16_f32 v41, v134, v135
    v_lshlrev_b32 v128, 16, v162
    v_and_b32 v129, s51, v162
    v_lshlrev_b32 v130, 16, v163
    v_and_b32 v131, s51, v163
    v_lshlrev_b32 v132, 16, v166
    v_and_b32 v133, s51, v166
    v_lshlrev_b32 v134, 16, v167
    v_and_b32 v135, s51, v167
    v_lshlrev_b32 v136, 16, v170
    v_and_b32 v137, s51, v170
    v_lshlrev_b32 v138, 16, v171
    v_and_b32 v139, s51, v171
    v_lshlrev_b32 v140, 16, v174
    v_and_b32 v141, s51, v174
    v_lshlrev_b32 v142, 16, v175
    v_and_b32 v143, s51, v175
    v_and_b32 v148, s51, v179
    v_lshlrev_b32 v149, 16, v179
    v_and_b32 v150, s51, v178
    v_lshlrev_b32 v151, 16, v178
    v_add_f32 v128, v128, v136
    v_add_f32 v129, v129, v137
    v_add_f32 v130, v130, v138
    v_add_f32 v131, v131, v139
    v_add_f32 v132, v132, v140
    v_add_f32 v133, v133, v141
    v_add_f32 v134, v134, v142
    v_add_f32 v135, v135, v143
    v_fma_f32 v128, v128, v148, -v132
    v_fma_f32 v129, v129, v149, -v133
    v_fma_f32 v130, v130, v150, -v134
    v_fma_f32 v131, v131, v151, -v135
    v_fmac_f32 v132, v128, v116
    v_fmac_f32 v133, v129, v117
    v_fmac_f32 v134, v130, v118
    v_fmac_f32 v135, v131, v119
    v_cvt_pk_bf16_f32 v42, v132, v133
    v_cvt_pk_bf16_f32 v43, v134, v135
    s_setprio 2
    buffer_store_dwordx2 v[40:41], v50, s[40:43], s55 offen offset:0
    buffer_store_dwordx2 v[42:43], v50, s[40:43], s55 offen offset:512
    v_sub_f32 v112, 1.0, v112
    v_sub_f32 v113, 1.0, v113
    v_sub_f32 v114, 1.0, v114
    v_sub_f32 v115, 1.0, v115
    v_sub_f32 v116, 1.0, v116
    v_sub_f32 v117, 1.0, v117
    v_sub_f32 v118, 1.0, v118
    v_sub_f32 v119, 1.0, v119
    s_mov_b32 s71, 294912
    v_mov_b32 v6, s45
    v_mov_b32 v7, s56
    v_mov_b32 v8, 1
    s_mov_b64 exec, 1
    s_waitcnt vmcnt(0)
    buffer_store_dword v6, v7, s[40:43], s74 offen offset:512
    ds_add_u32 v5, v8 offset:28
    s_mov_b64 exec, -1
L_bdw:
    ds_read_b128 v[24:27], v5 offset:64
    s_waitcnt lgkmcnt(0)
    v_and_b32 v24, v24, v25
    v_and_b32 v26, v26, v27
    v_and_b32 v24, v24, v26
    s_nop 0
    v_readfirstlane_b32 s68, v24
    s_cmp_eq_u32 s68, 1
    s_cbranch_scc0 L_bdw
    ds_read_b128 v[128:131], v44 offset:0
    ds_read_b128 v[132:135], v44 offset:18048
    ds_read_b128 v[136:139], v44 offset:36096
    ds_read_b128 v[140:143], v44 offset:54144
    ds_read_b128 v[144:147], v44 offset:1024
    ds_read_b128 v[148:151], v44 offset:19072
    ds_read_b128 v[152:155], v44 offset:37120
    ds_read_b128 v[156:159], v44 offset:55168
    s_waitcnt lgkmcnt(4)
    .p2align 3
    v_pk_add_f32 v[128:129], v[128:129], v[136:137]
    v_pk_add_f32 v[130:131], v[130:131], v[138:139]
    v_pk_add_f32 v[132:133], v[132:133], v[140:141]
    v_pk_add_f32 v[134:135], v[134:135], v[142:143]
    v_pk_fma_f32 v[128:129], v[128:129], v[112:113], v[64:65]
    v_pk_fma_f32 v[130:131], v[130:131], v[114:115], v[66:67]
    v_pk_fma_f32 v[132:133], v[132:133], v[112:113], v[68:69]
    v_pk_fma_f32 v[134:135], v[134:135], v[114:115], v[70:71]
    v_cvt_pk_bf16_f32 v32, v128, v132
    v_cvt_pk_bf16_f32 v33, v129, v133
    v_cvt_pk_bf16_f32 v34, v130, v134
    v_cvt_pk_bf16_f32 v35, v131, v135
    buffer_store_dwordx4 v[32:35], v47, s[96:99], 0 offen
    s_waitcnt lgkmcnt(0)
    .p2align 3
    v_pk_add_f32 v[144:145], v[144:145], v[152:153]
    v_pk_add_f32 v[146:147], v[146:147], v[154:155]
    v_pk_add_f32 v[148:149], v[148:149], v[156:157]
    v_pk_add_f32 v[150:151], v[150:151], v[158:159]
    v_pk_fma_f32 v[144:145], v[144:145], v[116:117], v[72:73]
    v_pk_fma_f32 v[146:147], v[146:147], v[118:119], v[74:75]
    v_pk_fma_f32 v[148:149], v[148:149], v[116:117], v[76:77]
    v_pk_fma_f32 v[150:151], v[150:151], v[118:119], v[78:79]
    v_cvt_pk_bf16_f32 v36, v144, v148
    v_cvt_pk_bf16_f32 v37, v145, v149
    v_cvt_pk_bf16_f32 v38, v146, v150
    v_cvt_pk_bf16_f32 v39, v147, v151
    buffer_store_dwordx4 v[36:39], v47, s[96:99], s71 offen
    v_mov_b32 v6, s45
    v_mov_b32 v7, s56
    v_mov_b32 v8, 1
    s_mov_b64 exec, 1
    s_waitcnt vmcnt(0)
    buffer_store_dword v6, v7, s[40:43], s74 offen offset:1024
    ds_add_u32 v5, v8 offset:12
    s_mov_b64 exec, -1
    s_lshl_b32 s68, s2, 3
    s_add_u32 s68, s68, s3
    s_cmp_lg_u32 s68, 4
    s_cbranch_scc1 L_fin
L_nw:
    ds_read_b32 v6, v5 offset:12
    s_waitcnt lgkmcnt(0)
    v_readfirstlane_b32 s68, v6
    s_cmp_lg_u32 s68, 4
    s_cbranch_scc1 L_nw
    v_mov_b32 v6, s44
    v_mov_b32 v7, 1409024
    buffer_store_dword v6, v7, s[40:43], 0 offen
    s_branch L_fin
L_bw:
    ds_read_b128 v[24:27], v5 offset:80
    ds_read_b32 v6, v5 offset:0
    s_waitcnt lgkmcnt(0)
    v_and_b32 v24, v25, v26
    v_and_b32 v6, v6, v27
    v_and_b32 v6, v6, v24
    s_nop 0
    v_readfirstlane_b32 s68, v6
    s_cmp_lg_u32 s68, 1
    s_cbranch_scc1 L_bw
    s_branch L_bw_ok
L_ew:
    ds_read_b32 v6, v5 offset:24
    s_waitcnt lgkmcnt(0)
    v_readfirstlane_b32 s68, v6
    s_cmp_lg_u32 s68, 4
    s_cbranch_scc1 L_ew
    s_branch L_ew_ok
L_end:
    s_endpgm
.section .rodata,"a"
.p2align 6

.amdhsa_kernel gated_mix__ssm_conv_h3__ssm_conv_s4d__prompt_kernel
  .amdhsa_next_free_vgpr 256
  .amdhsa_next_free_sgpr 100
  .amdhsa_accum_offset 256
  .amdhsa_group_segment_fixed_size 0
  .amdhsa_kernarg_size 136
  .amdhsa_user_sgpr_count 2
  .amdhsa_user_sgpr_kernarg_segment_ptr 1
  .amdhsa_system_sgpr_workgroup_id_x 1
  .amdhsa_float_denorm_mode_32 3
.end_amdhsa_kernel
```
